```python
import torch

def _softmax(x, axis=-1):
    return torch.softmax(x, dim=axis)
def _gelu(x):
    return torch.nn.functional.gelu(x, approximate="tanh")
def _silu(x):
    return torch.nn.functional.silu(x)
def _sigmoid(x):
    return torch.sigmoid(x)
def _layernorm(x, axis=-1, eps=1e-5):
    m = x.mean(dim=axis, keepdim=True)
    v = x.var(dim=axis, keepdim=True, unbiased=False)
    return (x - m) / torch.sqrt(v + eps)
def _scatter_add(tgt, idx, src, axis=0):
    return tgt.clone().index_add_(axis, idx, src)
def _segment_sum(src, seg, n):
    out = torch.zeros((n,) + src.shape[1:], dtype=src.dtype)
    return out.index_add_(0, seg, src)
def _pad(x, pw):
    flat = tuple(v for pair in reversed(pw) for v in pair)
    return torch.nn.functional.pad(x, flat)

kernel_name = 'sequential_preLN__ssm_conv_s4__dense_activation_relu__prompt'

def setup_inputs():

    _w = (lambda a: (lambda t: t.to(torch.bfloat16) if t.is_floating_point() else t)(torch.as_tensor(a)))
    def _A_setup():
        B, L, D, N = 1, 2048, 640, 128
        A_re = -(lambda _x: torch.exp(torch.as_tensor(_x)))((lambda *s: torch.randn(*s, dtype=torch.bfloat16) * 3.2)(D, N))
        A_im = torch.pi * (lambda *s: torch.randn(*s, dtype=torch.bfloat16) * 0.05)(D, N)
        B_re = (lambda *s: torch.randn(*s, dtype=torch.bfloat16) * 0.1)(D, N)
        B_im = (lambda *s: torch.randn(*s, dtype=torch.bfloat16) * 0.1)(D, N)
        C_re = (lambda *s: torch.randn(*s, dtype=torch.bfloat16) * 0.1)(D, N)
        C_im = (lambda *s: torch.randn(*s, dtype=torch.bfloat16) * 0.1)(D, N)
        log_dt = (lambda *s: torch.randn(*s, dtype=torch.bfloat16) * 0.05)(D) * 0.5 - 4.0
        Dskip = (lambda *s: torch.randn(*s, dtype=torch.bfloat16) * 0.05)(D)
        return {
            "u": _w((lambda *s: torch.randn(*s, dtype=torch.bfloat16) * 0.05)(B, L, D)),
            "A_re": _w(A_re),
            "A_im": _w(A_im),
            "B_re": _w(B_re),
            "B_im": _w(B_im),
            "C_re": _w(C_re),
            "C_im": _w(C_im),
            "log_dt": _w(log_dt),
            "Dskip": _w(Dskip),
        }
    _A_in = _A_setup()

    def _B_setup():
        B, S, D, Dff = 1, 2048, 640, 1728
        return {
            "x": _w((lambda *s: torch.randn(*s, dtype=torch.bfloat16) * 0.05)(B, S, D)),
            "w1": _w((lambda *s: torch.randn(*s, dtype=torch.bfloat16) * 0.05)(D, Dff)),
            "w2": _w((lambda *s: torch.randn(*s, dtype=torch.bfloat16) * 0.05)(Dff, D)),
        }
    _B_in = _B_setup()

    return {
        "A_u": _A_in["u"],
        "A_A_re": _A_in["A_re"],
        "A_A_im": _A_in["A_im"],
        "A_B_re": _A_in["B_re"],
        "A_B_im": _A_in["B_im"],
        "A_C_re": _A_in["C_re"],
        "A_C_im": _A_in["C_im"],
        "A_log_dt": _A_in["log_dt"],
        "A_Dskip": _A_in["Dskip"],
        "B_x": _B_in["x"],
        "B_w1": _B_in["w1"],
        "B_w2": _B_in["w2"],
    }

def reference(A_u, A_A_re, A_A_im, A_B_re, A_B_im, A_C_re, A_C_im, A_log_dt, A_Dskip, B_x, B_w1, B_w2):
    def _A_ref(u, A_re, A_im, B_re, B_im, C_re, C_im, log_dt, Dskip):
        Bsz, L, D = u.shape
        dt = torch.exp(log_dt)[:, None]
        A = A_re + 1j * A_im
        Bc = B_re + 1j * B_im
        Cc = C_re + 1j * C_im
        logdA = dt * A
        dB = dt * Bc
        l = (lambda x, dt: x.to(dt))(torch.arange(L), A_re.dtype)
        P = torch.exp(logdA[:, :, None] * l[None, None, :])
        K = torch.einsum("dn,dnl,dn->dl", Cc, P, dB).real
        L2 = 2 * L
        Kp = _pad(K, ((0, 0), (0, L)))
        up = (lambda x, *d: x.permute(*d))(u, 0, 2, 1)
        up = _pad(up, ((0, 0), (0, 0), (0, L)))
        Kf = (lambda x, axes=(-2,-1): torch.fft.rfft2(x.float(), dim=axes))(Kp[:, None, :], axes=(-2, -1))
        Uf = (lambda x, axes=(-2,-1): torch.fft.rfft2(x.float(), dim=axes))(up[:, :, None, :], axes=(-2, -1))
        Yf = Uf * Kf[None, :, :, :]
        y = (lambda x, s, axes=(-2,-1): torch.fft.irfft2(x, s=s, dim=axes).to(torch.bfloat16))(Yf, (1, L2), axes=(-2, -1))[:, :, 0, :L]
        y = (lambda x, *d: x.permute(*d))(y, 0, 2, 1) + u * Dskip[None, None, :]
        return y

    def _B_ref(x, w1, w2):
        h = torch.einsum("bsd,df->bsf", x, w1)
        zero = torch.zeros_like(h)
        h = torch.maximum(h, zero)
        return torch.einsum("bsf,fd->bsd", h, w2)

    x = A_u
    h = x + _A_ref(_layernorm(x, axis=-1), A_A_re, A_A_im, A_B_re, A_B_im, A_C_re, A_C_im, A_log_dt, A_Dskip)
    h2 = h + _B_ref(_layernorm(h, axis=-1), B_w1, B_w2)
    return h2
```

```asm
; @launch grid=(256,1,1) block=(256,1,1) lds=163840
.amdgcn_target "amdgcn-amd-amdhsa--gfx950"
.text
.globl sequential_preLN__ssm_conv_s4__dense_activation_relu__prompt_kernel
.p2align 8
.type sequential_preLN__ssm_conv_s4__dense_activation_relu__prompt_kernel,@function
sequential_preLN__ssm_conv_s4__dense_activation_relu__prompt_kernel:
    s_load_dwordx16 s[16:31], s[0:1], 0
    s_load_dwordx8 s[32:39], s[0:1], 64
    s_load_dwordx4 s[40:43], s[0:1], 96
    s_load_dwordx2 s[44:45], s[0:1], 112
    s_memrealtime s[4:5]
    s_cmp_ge_u32 s2, 256
    s_cbranch_scc1 L_END
    v_lshrrev_b32 v1, 6, v0
    s_nop 0
    v_readfirstlane_b32 s3, v1
    v_and_b32 v1, 63, v0
    s_cmp_lt_u32 s2, 160
    s_cbranch_scc1 L_CONV
    s_cmp_eq_u32 s3, 3
    s_cbranch_scc1 L_AUX3
    s_sub_u32 s60, s2, 160
    s_mul_i32 s57, s60, 3
    s_add_u32 s57, s57, s3
    v_lshrrev_b32 v2, 3, v1
    v_mul_u32_u24 v2, 1280, v2
    v_and_b32 v3, 7, v1
    v_lshl_add_u32 v2, v3, 4, v2
    s_mul_i32 s6, s57, 10240
    s_waitcnt lgkmcnt(0)
    s_mov_b32 s8, s16
    s_mov_b32 s9, s17
    s_nop 0
    s_mov_b32 s10, 0x280000
    s_mov_b32 s11, 0x20000
    buffer_load_dwordx4 v[16:19], v2, s[8:11], s6 offen offset:0
    buffer_load_dwordx4 v[20:23], v2, s[8:11], s6 offen offset:128
    buffer_load_dwordx4 v[24:27], v2, s[8:11], s6 offen offset:256
    buffer_load_dwordx4 v[28:31], v2, s[8:11], s6 offen offset:384
    buffer_load_dwordx4 v[32:35], v2, s[8:11], s6 offen offset:512
    buffer_load_dwordx4 v[36:39], v2, s[8:11], s6 offen offset:640
    buffer_load_dwordx4 v[40:43], v2, s[8:11], s6 offen offset:768
    buffer_load_dwordx4 v[44:47], v2, s[8:11], s6 offen offset:896
    buffer_load_dwordx4 v[48:51], v2, s[8:11], s6 offen offset:1024
    buffer_load_dwordx4 v[52:55], v2, s[8:11], s6 offen offset:1152
    s_branch L_AUX
L_AUX3:
    v_mov_b32 v14, 0
    v_mov_b32 v13, 0
    s_waitcnt lgkmcnt(0)
    s_mov_b32 s68, s42
    s_mov_b32 s69, s43
    s_mov_b32 s70, 0x100
    s_mov_b32 s71, 0x20000
    s_or_b32 s4, s4, 1
    v_mov_b32 v12, s4
    s_mov_b64 exec, 1
    buffer_atomic_cmpswap v[12:13], v14, s[68:71], 0 offen sc0 sc1
    s_mov_b64 exec, -1
    s_mov_b32 s64, s44
    s_mov_b32 s65, s45
    s_mov_b32 s66, 0x28000
    s_mov_b32 s67, 0x20000
    s_sub_u32 s6, s2, 160
    s_lshl_b32 s6, s6, 13
    v_lshlrev_b32 v2, 7, v1
    buffer_load_dword v245, v2, s[64:67], s6 offen sc1
    s_getpc_b64 s[6:7]
L_PC:
    s_sub_u32 s6, s6, L_PC-sequential_preLN__ssm_conv_s4__dense_activation_relu__prompt_kernel
    s_subb_u32 s7, s7, 0
    v_lshlrev_b32_e64 v2, 7, v1
    v_min_u32 v3, L_END-sequential_preLN__ssm_conv_s4__dense_activation_relu__prompt_kernel, v2
    global_load_dword v244, v3, s[6:7]
    v_add_u32 v2, 8192, v2
    v_min_u32 v3, L_END-sequential_preLN__ssm_conv_s4__dense_activation_relu__prompt_kernel, v2
    global_load_dword v244, v3, s[6:7]
    v_add_u32 v2, 8192, v2
    v_min_u32 v3, L_END-sequential_preLN__ssm_conv_s4__dense_activation_relu__prompt_kernel, v2
    global_load_dword v244, v3, s[6:7]
    v_add_u32 v2, 8192, v2
    v_min_u32 v3, L_END-sequential_preLN__ssm_conv_s4__dense_activation_relu__prompt_kernel, v2
    global_load_dword v244, v3, s[6:7]
    v_add_u32 v2, 8192, v2
    v_min_u32 v3, L_END-sequential_preLN__ssm_conv_s4__dense_activation_relu__prompt_kernel, v2
    global_load_dword v244, v3, s[6:7]
    v_add_u32 v2, 8192, v2
    s_branch L_AUX3B
L_CONV:
    s_waitcnt lgkmcnt(0)
    s_and_b32 s6, s2, 7
    s_mul_i32 s6, s6, 20
    s_lshr_b32 s7, s2, 3
    s_add_u32 s60, s6, s7
    s_lshl_b32 s6, s60, 2
    s_add_u32 s6, s6, s3
    s_lshl_b32 s5, s6, 8
    v_lshl_add_u32 v2, v1, 2, s5
    s_lshl_b32 s5, s6, 1
    v_mov_b32_e64 v3, s5
    global_load_ushort v14, v3, s[30:31]
    global_load_dword v8, v2, s[18:19]
    global_load_dword v9, v2, s[20:21]
    global_load_dword v10, v2, s[22:23]
    global_load_dword v11, v2, s[24:25]
    global_load_dword v12, v2, s[26:27]
    global_load_dword v13, v2, s[28:29]
    global_load_ushort v15, v3, s[32:33]
    s_mov_b32 s73, 400000
    s_getreg_b32 s0, hwreg(HW_REG_XCC_ID, 0, 4)
    s_mov_b32 s68, s42
    s_mov_b32 s69, s43
    s_mov_b32 s70, 0x100
    s_mov_b32 s71, 0x20000
    s_mov_b32 s64, s44
    s_mov_b32 s65, s45
    s_nop 0
    s_mov_b32 s66, 0x28000
    s_mov_b32 s67, 0x20000
    s_mul_i32 s61, s3, 23296
    s_mul_i32 s59, s3, 8256
    s_add_u32 s59, s59, 93184
    s_mov_b32 s8, s16
    s_mov_b32 s9, s17
    s_mov_b32 s10, 0x280000
    s_mov_b32 s11, 0x20000
    v_mul_u32_u24 v7, 10240, v0
    s_lshl_b32 s6, s60, 3
    s_add_u32 s7, s6, 5120
    s_barrier
    buffer_load_dwordx2 v[232:233], v7, s[8:11], s6 offen offset:0
    buffer_load_dwordx2 v[234:235], v7, s[8:11], s6 offen offset:1280
    buffer_load_dwordx2 v[236:237], v7, s[8:11], s6 offen offset:2560
    buffer_load_dwordx2 v[238:239], v7, s[8:11], s6 offen offset:3840
    buffer_load_dwordx2 v[240:241], v7, s[8:11], s7 offen offset:0
    s_mov_b32 s48, 3232
    s_and_b32 s49, s2, 7
    s_lshl_b32 s49, s49, 4
    s_add_u32 s49, s49, s2
    s_bfe_u32 s49, s49, 0x40003
    s_bitcmp1_b32 s49, 0
    s_cselect_b32 s49, 0, 208
    v_mov_b32 v231, 1048576
    v_add_u32 v24, 0, v0
    v_mul_u32_u24 v25, 4682, v24
    v_lshrrev_b32 v25, 16, v25
    v_lshlrev_b32 v24, 4, v24
    v_mad_u32_u24 v248, v25, s48, v24
    v_mul_u32_u24 v25, 224, v25
    v_sub_u32 v25, v24, v25
    v_cmp_eq_u32 vcc, s49, v25
    s_nop 1
    v_cndmask_b32 v231, v231, v24, vcc
    v_add_u32 v24, 256, v0
    v_mul_u32_u24 v25, 4682, v24
    v_lshrrev_b32 v25, 16, v25
    v_lshlrev_b32 v24, 4, v24
    v_mad_u32_u24 v249, v25, s48, v24
    v_mul_u32_u24 v25, 224, v25
    v_sub_u32 v25, v24, v25
    v_cmp_eq_u32 vcc, s49, v25
    s_nop 1
    v_cndmask_b32 v231, v231, v24, vcc
    v_add_u32 v24, 512, v0
    v_mul_u32_u24 v25, 4682, v24
    v_lshrrev_b32 v25, 16, v25
    v_lshlrev_b32 v24, 4, v24
    v_mad_u32_u24 v250, v25, s48, v24
    v_mul_u32_u24 v25, 224, v25
    v_sub_u32 v25, v24, v25
    v_cmp_eq_u32 vcc, s49, v25
    s_nop 1
    v_cndmask_b32 v231, v231, v24, vcc
    v_add_u32 v24, 768, v0
    v_mul_u32_u24 v25, 4682, v24
    v_lshrrev_b32 v25, 16, v25
    v_lshlrev_b32 v24, 4, v24
    v_mad_u32_u24 v251, v25, s48, v24
    v_mul_u32_u24 v25, 224, v25
    v_sub_u32 v25, v24, v25
    v_cmp_eq_u32 vcc, s49, v25
    s_nop 1
    v_cndmask_b32 v231, v231, v24, vcc
    v_add_u32 v24, 1024, v0
    v_mul_u32_u24 v25, 4682, v24
    v_lshrrev_b32 v25, 16, v25
    v_lshlrev_b32 v24, 4, v24
    v_mad_u32_u24 v252, v25, s48, v24
    v_mul_u32_u24 v25, 224, v25
    v_sub_u32 v25, v24, v25
    v_cmp_eq_u32 vcc, s49, v25
    s_nop 1
    v_cndmask_b32 v231, v231, v24, vcc
    v_add_u32 v24, 1280, v0
    v_mul_u32_u24 v25, 4682, v24
    v_lshrrev_b32 v25, 16, v25
    v_lshlrev_b32 v24, 4, v24
    v_mad_u32_u24 v253, v25, s48, v24
    v_mul_u32_u24 v25, 224, v25
    v_sub_u32 v25, v24, v25
    v_cmp_eq_u32 vcc, s49, v25
    s_nop 1
    v_cndmask_b32 v231, v231, v24, vcc
    v_add_u32 v24, 1536, v0
    v_mul_u32_u24 v25, 4682, v24
    v_lshrrev_b32 v25, 16, v25
    v_lshlrev_b32 v24, 4, v24
    v_mad_u32_u24 v254, v25, s48, v24
    v_mul_u32_u24 v25, 224, v25
    v_sub_u32 v25, v24, v25
    v_cmp_eq_u32 vcc, s49, v25
    s_nop 1
    v_cndmask_b32 v231, v231, v24, vcc
    v_lshl_add_u32 v4, v1, 3, s61
    v_and_b32 v16, 15, v1
    v_lshrrev_b32 v17, 4, v1
    v_and_b32 v18, 1, v17
    v_lshlrev_b32 v18, 8, v18
    v_lshrrev_b32 v19, 1, v17
    v_lshl_add_u32 v18, v19, 7, v18
    v_add_u32 v18, s61, v18
    v_mul_u32_u24 v19, 528, v16
    v_add_u32 v5, v18, v19
    v_min_u32 v19, 8, v16
    v_mul_u32_u24 v19, 528, v19
    v_add_u32 v6, v18, v19
    s_mov_b32 s50, 0x3fb8aa3b
    s_mov_b32 s51, 0x32a57060
    s_mov_b32 s52, 0x41800000
    s_mov_b32 s53, 0x41800000
    s_mov_b32 s54, 0x44000000
    s_mov_b32 s55, 0x44000000
    s_add_u32 s56, s61, 16
    v_lshlrev_b32 v224, 6, v16
    v_lshl_add_u32 v224, v17, 4, v224
    v_lshrrev_b32 v225, 1, v224
    v_add_u32 v224, s56, v224
    v_add_u32 v225, s56, v225
    v_add_u32 v225, 1024, v225
    v_cmp_eq_u32 vcc, 0, v17
    v_mov_b32_e64 v30, 8
    v_mov_b32 v31, 256
    v_cndmask_b32 v30, v30, 16, vcc
    v_cndmask_b32 v31, v31, 8, vcc
    v_lshlrev_b32 v226, 9, v17
    v_mad_u32_u24 v226, v30, v16, v226
    v_add_u32 v226, s56, v226
    v_add_u32 v227, v226, v31
    v_lshl_add_u32 v228, v30, 4, v226
    v_add_u32 v229, v228, v31
    s_waitcnt vmcnt(12)
    v_lshlrev_b32 v21, 16, v14
    v_mul_f32 v22, s50, v21
    v_fma_f32 v23, v21, s50, -v22
    v_fma_f32 v23, v21, s51, v23
    v_exp_f32 v22, v22
    v_mul_f32 v23, 0x3f317218, v23
    v_fma_f32 v22, v22, v23, v22
    v_cvt_pk_bf16_f32 v22, v22, v22
    v_lshlrev_b32 v20, 16, v22
    v_mul_f32 v22, s50, v20
    v_mul_f32 v23, 0.15915494, v20
    s_waitcnt vmcnt(5)
    v_lshlrev_b32 v24, 16, v8
    v_and_b32 v26, 0xffff0000, v8
    v_lshlrev_b32 v25, 16, v9
    v_and_b32 v27, 0xffff0000, v9
    v_lshlrev_b32 v28, 16, v10
    v_and_b32 v30, 0xffff0000, v10
    v_lshlrev_b32 v29, 16, v11
    v_and_b32 v31, 0xffff0000, v11
    v_lshlrev_b32 v32, 16, v12
    v_and_b32 v34, 0xffff0000, v12
    v_lshlrev_b32 v33, 16, v13
    v_and_b32 v35, 0xffff0000, v13
    v_pk_mul_f32 v[24:25], v[24:25], v[22:23]
    v_pk_mul_f32 v[26:27], v[26:27], v[22:23]
    v_pk_mul_f32 v[28:29], v[28:29], v[20:21] op_sel_hi:[1,0]
    v_pk_mul_f32 v[30:31], v[30:31], v[20:21] op_sel_hi:[1,0]
    v_pk_mul_f32 v[60:61], v[24:25], s[52:53]
    v_pk_mul_f32 v[64:65], v[24:25], s[54:55]
    v_pk_mul_f32 v[62:63], v[26:27], s[52:53]
    v_pk_mul_f32 v[66:67], v[26:27], s[54:55]
    v_pk_mul_f32 v[36:37], v[32:33], v[28:29] op_sel:[0,0] op_sel_hi:[1,0]
    v_pk_mul_f32 v[38:39], v[34:35], v[30:31] op_sel:[0,0] op_sel_hi:[1,0]
    v_pk_fma_f32 v[40:41], v[32:33], v[28:29], v[36:37] op_sel:[1,1,0] op_sel_hi:[0,1,1] neg_lo:[1,0,0]
    v_pk_fma_f32 v[42:43], v[34:35], v[30:31], v[38:39] op_sel:[1,1,0] op_sel_hi:[0,1,1] neg_lo:[1,0,0]
    v_fract_f32 v57, v25
    v_fract_f32 v59, v27
    v_fract_f32 v61, v61
    v_fract_f32 v63, v63
    v_fract_f32 v65, v65
    v_fract_f32 v67, v67
    v_xor_b32 v41, 0x80000000, v41
    v_xor_b32 v43, 0x80000000, v43
    v_exp_f32 v68, v24
    v_cos_f32 v44, v57
    v_sin_f32 v45, v57
    v_exp_f32 v70, v26
    v_cos_f32 v46, v59
    v_sin_f32 v47, v59
    v_exp_f32 v72, v60
    v_cos_f32 v48, v61
    v_sin_f32 v49, v61
    v_exp_f32 v74, v62
    v_cos_f32 v50, v63
    v_sin_f32 v51, v63
    v_exp_f32 v76, v64
    v_cos_f32 v52, v65
    v_sin_f32 v53, v65
    v_exp_f32 v78, v66
    v_cos_f32 v54, v67
    v_sin_f32 v55, v67
    v_pk_mul_f32 v[44:45], v[44:45], v[68:69] op_sel_hi:[1,0]
    v_pk_mul_f32 v[46:47], v[46:47], v[70:71] op_sel_hi:[1,0]
    v_pk_mul_f32 v[48:49], v[48:49], v[72:73] op_sel_hi:[1,0] neg_hi:[1,0]
    v_pk_mul_f32 v[50:51], v[50:51], v[74:75] op_sel_hi:[1,0] neg_hi:[1,0]
    v_pk_mul_f32 v[52:53], v[52:53], v[76:77] op_sel_hi:[1,0]
    v_pk_mul_f32 v[54:55], v[54:55], v[78:79] op_sel_hi:[1,0]
    v_mov_b32 v220, 0x3f80
    v_mov_b32 v221, 0x3f80
    ds_write_b64 v4, v[220:221] offset:0
    v_cvt_pk_bf16_f32 v80, v40, v41
    v_cvt_pk_bf16_f32 v81, v42, v43
    v_cvt_pk_bf16_f32 v82, v44, v45
    v_cvt_pk_bf16_f32 v83, v46, v47
    ds_write_b64 v4, v[80:81] offset:13200
    ds_write_b64 v4, v[82:83] offset:528
    v_pk_mul_f32 v[36:37], v[40:41], v[48:49] op_sel:[0,0] op_sel_hi:[1,0]
    v_pk_mul_f32 v[38:39], v[42:43], v[50:51] op_sel:[0,0] op_sel_hi:[1,0]
    v_pk_mul_f32 v[216:217], v[44:45], v[44:45] op_sel:[0,0] op_sel_hi:[1,0]
    v_pk_mul_f32 v[218:219], v[46:47], v[46:47] op_sel:[0,0] op_sel_hi:[1,0]
    v_pk_fma_f32 v[40:41], v[40:41], v[48:49], v[36:37] op_sel:[1,1,0] op_sel_hi:[0,1,1] neg_lo:[1,0,0]
    v_pk_fma_f32 v[42:43], v[42:43], v[50:51], v[38:39] op_sel:[1,1,0] op_sel_hi:[0,1,1] neg_lo:[1,0,0]
    v_pk_fma_f32 v[68:69], v[44:45], v[44:45], v[216:217] op_sel:[1,1,0] op_sel_hi:[0,1,1] neg_lo:[1,0,0]
    v_pk_fma_f32 v[70:71], v[46:47], v[46:47], v[218:219] op_sel:[1,1,0] op_sel_hi:[0,1,1] neg_lo:[1,0,0]
    v_cvt_pk_bf16_f32 v84, v40, v41
    v_cvt_pk_bf16_f32 v85, v42, v43
    v_cvt_pk_bf16_f32 v86, v68, v69
    v_cvt_pk_bf16_f32 v87, v70, v71
    ds_write_b64 v4, v[84:85] offset:13728
    ds_write_b64 v4, v[86:87] offset:1056
    v_pk_mul_f32 v[36:37], v[40:41], v[48:49] op_sel:[0,0] op_sel_hi:[1,0]
    v_pk_mul_f32 v[38:39], v[42:43], v[50:51] op_sel:[0,0] op_sel_hi:[1,0]
    v_pk_mul_f32 v[216:217], v[68:69], v[44:45] op_sel:[0,0] op_sel_hi:[1,0]
    v_pk_mul_f32 v[218:219], v[70:71], v[46:47] op_sel:[0,0] op_sel_hi:[1,0]
    v_pk_fma_f32 v[40:41], v[40:41], v[48:49], v[36:37] op_sel:[1,1,0] op_sel_hi:[0,1,1] neg_lo:[1,0,0]
    v_pk_fma_f32 v[42:43], v[42:43], v[50:51], v[38:39] op_sel:[1,1,0] op_sel_hi:[0,1,1] neg_lo:[1,0,0]
    v_pk_fma_f32 v[68:69], v[68:69], v[44:45], v[216:217] op_sel:[1,1,0] op_sel_hi:[0,1,1] neg_lo:[1,0,0]
    v_pk_fma_f32 v[70:71], v[70:71], v[46:47], v[218:219] op_sel:[1,1,0] op_sel_hi:[0,1,1] neg_lo:[1,0,0]
    v_cvt_pk_bf16_f32 v80, v40, v41
    v_cvt_pk_bf16_f32 v81, v42, v43
    v_cvt_pk_bf16_f32 v82, v68, v69
    v_cvt_pk_bf16_f32 v83, v70, v71
    ds_write_b64 v4, v[80:81] offset:14256
    ds_write_b64 v4, v[82:83] offset:1584
    v_pk_mul_f32 v[36:37], v[40:41], v[48:49] op_sel:[0,0] op_sel_hi:[1,0]
    v_pk_mul_f32 v[38:39], v[42:43], v[50:51] op_sel:[0,0] op_sel_hi:[1,0]
    v_pk_mul_f32 v[216:217], v[68:69], v[44:45] op_sel:[0,0] op_sel_hi:[1,0]
    v_pk_mul_f32 v[218:219], v[70:71], v[46:47] op_sel:[0,0] op_sel_hi:[1,0]
    v_pk_fma_f32 v[40:41], v[40:41], v[48:49], v[36:37] op_sel:[1,1,0] op_sel_hi:[0,1,1] neg_lo:[1,0,0]
    v_pk_fma_f32 v[42:43], v[42:43], v[50:51], v[38:39] op_sel:[1,1,0] op_sel_hi:[0,1,1] neg_lo:[1,0,0]
    v_pk_fma_f32 v[56:57], v[68:69], v[44:45], v[216:217] op_sel:[1,1,0] op_sel_hi:[0,1,1] neg_lo:[1,0,0]
    v_pk_fma_f32 v[58:59], v[70:71], v[46:47], v[218:219] op_sel:[1,1,0] op_sel_hi:[0,1,1] neg_lo:[1,0,0]
    v_cvt_pk_bf16_f32 v84, v40, v41
    v_cvt_pk_bf16_f32 v85, v42, v43
    v_cvt_pk_bf16_f32 v86, v56, v57
    v_cvt_pk_bf16_f32 v87, v58, v59
    ds_write_b64 v4, v[84:85] offset:14784
    ds_write_b64 v4, v[86:87] offset:2112
    v_pk_mul_f32 v[36:37], v[40:41], v[48:49] op_sel:[0,0] op_sel_hi:[1,0]
    v_pk_mul_f32 v[38:39], v[42:43], v[50:51] op_sel:[0,0] op_sel_hi:[1,0]
    v_pk_mul_f32 v[216:217], v[56:57], v[44:45] op_sel:[0,0] op_sel_hi:[1,0]
    v_pk_mul_f32 v[218:219], v[58:59], v[46:47] op_sel:[0,0] op_sel_hi:[1,0]
    v_pk_fma_f32 v[40:41], v[40:41], v[48:49], v[36:37] op_sel:[1,1,0] op_sel_hi:[0,1,1] neg_lo:[1,0,0]
    v_pk_fma_f32 v[42:43], v[42:43], v[50:51], v[38:39] op_sel:[1,1,0] op_sel_hi:[0,1,1] neg_lo:[1,0,0]
    v_pk_fma_f32 v[68:69], v[56:57], v[44:45], v[216:217] op_sel:[1,1,0] op_sel_hi:[0,1,1] neg_lo:[1,0,0]
    v_pk_fma_f32 v[70:71], v[58:59], v[46:47], v[218:219] op_sel:[1,1,0] op_sel_hi:[0,1,1] neg_lo:[1,0,0]
    v_cvt_pk_bf16_f32 v80, v40, v41
    v_cvt_pk_bf16_f32 v81, v42, v43
    v_cvt_pk_bf16_f32 v82, v68, v69
    v_cvt_pk_bf16_f32 v83, v70, v71
    ds_write_b64 v4, v[80:81] offset:15312
    ds_write_b64 v4, v[82:83] offset:2640
    v_pk_mul_f32 v[36:37], v[40:41], v[48:49] op_sel:[0,0] op_sel_hi:[1,0]
    v_pk_mul_f32 v[38:39], v[42:43], v[50:51] op_sel:[0,0] op_sel_hi:[1,0]
    v_pk_mul_f32 v[216:217], v[68:69], v[44:45] op_sel:[0,0] op_sel_hi:[1,0]
    v_pk_mul_f32 v[218:219], v[70:71], v[46:47] op_sel:[0,0] op_sel_hi:[1,0]
    v_pk_fma_f32 v[40:41], v[40:41], v[48:49], v[36:37] op_sel:[1,1,0] op_sel_hi:[0,1,1] neg_lo:[1,0,0]
    v_pk_fma_f32 v[42:43], v[42:43], v[50:51], v[38:39] op_sel:[1,1,0] op_sel_hi:[0,1,1] neg_lo:[1,0,0]
    v_pk_fma_f32 v[68:69], v[68:69], v[44:45], v[216:217] op_sel:[1,1,0] op_sel_hi:[0,1,1] neg_lo:[1,0,0]
    v_pk_fma_f32 v[70:71], v[70:71], v[46:47], v[218:219] op_sel:[1,1,0] op_sel_hi:[0,1,1] neg_lo:[1,0,0]
    v_cvt_pk_bf16_f32 v84, v40, v41
    v_cvt_pk_bf16_f32 v85, v42, v43
    v_cvt_pk_bf16_f32 v86, v68, v69
    v_cvt_pk_bf16_f32 v87, v70, v71
    ds_write_b64 v4, v[84:85] offset:15840
    ds_write_b64 v4, v[86:87] offset:3168
    v_pk_mul_f32 v[36:37], v[40:41], v[48:49] op_sel:[0,0] op_sel_hi:[1,0]
    v_pk_mul_f32 v[38:39], v[42:43], v[50:51] op_sel:[0,0] op_sel_hi:[1,0]
    v_pk_mul_f32 v[216:217], v[68:69], v[44:45] op_sel:[0,0] op_sel_hi:[1,0]
    v_pk_mul_f32 v[218:219], v[70:71], v[46:47] op_sel:[0,0] op_sel_hi:[1,0]
    v_pk_fma_f32 v[40:41], v[40:41], v[48:49], v[36:37] op_sel:[1,1,0] op_sel_hi:[0,1,1] neg_lo:[1,0,0]
    v_pk_fma_f32 v[42:43], v[42:43], v[50:51], v[38:39] op_sel:[1,1,0] op_sel_hi:[0,1,1] neg_lo:[1,0,0]
    v_pk_fma_f32 v[68:69], v[68:69], v[44:45], v[216:217] op_sel:[1,1,0] op_sel_hi:[0,1,1] neg_lo:[1,0,0]
    v_pk_fma_f32 v[70:71], v[70:71], v[46:47], v[218:219] op_sel:[1,1,0] op_sel_hi:[0,1,1] neg_lo:[1,0,0]
    v_cvt_pk_bf16_f32 v80, v40, v41
    v_cvt_pk_bf16_f32 v81, v42, v43
    v_cvt_pk_bf16_f32 v82, v68, v69
    v_cvt_pk_bf16_f32 v83, v70, v71
    ds_write_b64 v4, v[80:81] offset:16368
    ds_write_b64 v4, v[82:83] offset:3696
    buffer_load_dwordx2 v[242:243], v7, s[8:11], s7 offen offset:1280
    v_pk_mul_f32 v[36:37], v[40:41], v[48:49] op_sel:[0,0] op_sel_hi:[1,0]
    v_pk_mul_f32 v[38:39], v[42:43], v[50:51] op_sel:[0,0] op_sel_hi:[1,0]
    v_pk_mul_f32 v[216:217], v[68:69], v[44:45] op_sel:[0,0] op_sel_hi:[1,0]
    v_pk_mul_f32 v[218:219], v[70:71], v[46:47] op_sel:[0,0] op_sel_hi:[1,0]
    v_pk_fma_f32 v[40:41], v[40:41], v[48:49], v[36:37] op_sel:[1,1,0] op_sel_hi:[0,1,1] neg_lo:[1,0,0]
    v_pk_fma_f32 v[42:43], v[42:43], v[50:51], v[38:39] op_sel:[1,1,0] op_sel_hi:[0,1,1] neg_lo:[1,0,0]
    v_pk_fma_f32 v[60:61], v[68:69], v[44:45], v[216:217] op_sel:[1,1,0] op_sel_hi:[0,1,1] neg_lo:[1,0,0]
    v_pk_fma_f32 v[62:63], v[70:71], v[46:47], v[218:219] op_sel:[1,1,0] op_sel_hi:[0,1,1] neg_lo:[1,0,0]
    v_cvt_pk_bf16_f32 v84, v40, v41
    v_cvt_pk_bf16_f32 v85, v42, v43
    v_cvt_pk_bf16_f32 v86, v60, v61
    v_cvt_pk_bf16_f32 v87, v62, v63
    ds_write_b64 v4, v[84:85] offset:16896
    ds_write_b64 v4, v[86:87] offset:4224
    v_pk_mul_f32 v[36:37], v[40:41], v[48:49] op_sel:[0,0] op_sel_hi:[1,0]
    v_pk_mul_f32 v[38:39], v[42:43], v[50:51] op_sel:[0,0] op_sel_hi:[1,0]
    v_pk_mul_f32 v[216:217], v[60:61], v[44:45] op_sel:[0,0] op_sel_hi:[1,0]
    v_pk_mul_f32 v[218:219], v[62:63], v[46:47] op_sel:[0,0] op_sel_hi:[1,0]
    v_pk_fma_f32 v[40:41], v[40:41], v[48:49], v[36:37] op_sel:[1,1,0] op_sel_hi:[0,1,1] neg_lo:[1,0,0]
    v_pk_fma_f32 v[42:43], v[42:43], v[50:51], v[38:39] op_sel:[1,1,0] op_sel_hi:[0,1,1] neg_lo:[1,0,0]
    v_pk_fma_f32 v[68:69], v[60:61], v[44:45], v[216:217] op_sel:[1,1,0] op_sel_hi:[0,1,1] neg_lo:[1,0,0]
    v_pk_fma_f32 v[70:71], v[62:63], v[46:47], v[218:219] op_sel:[1,1,0] op_sel_hi:[0,1,1] neg_lo:[1,0,0]
    v_cvt_pk_bf16_f32 v80, v40, v41
    v_cvt_pk_bf16_f32 v81, v42, v43
    v_cvt_pk_bf16_f32 v82, v68, v69
    v_cvt_pk_bf16_f32 v83, v70, v71
    ds_write_b64 v4, v[80:81] offset:17424
    ds_write_b64 v4, v[82:83] offset:4752
    v_pk_mul_f32 v[36:37], v[40:41], v[48:49] op_sel:[0,0] op_sel_hi:[1,0]
    v_pk_mul_f32 v[38:39], v[42:43], v[50:51] op_sel:[0,0] op_sel_hi:[1,0]
    v_pk_mul_f32 v[216:217], v[68:69], v[44:45] op_sel:[0,0] op_sel_hi:[1,0]
    v_pk_mul_f32 v[218:219], v[70:71], v[46:47] op_sel:[0,0] op_sel_hi:[1,0]
    v_pk_fma_f32 v[40:41], v[40:41], v[48:49], v[36:37] op_sel:[1,1,0] op_sel_hi:[0,1,1] neg_lo:[1,0,0]
    v_pk_fma_f32 v[42:43], v[42:43], v[50:51], v[38:39] op_sel:[1,1,0] op_sel_hi:[0,1,1] neg_lo:[1,0,0]
    v_pk_fma_f32 v[68:69], v[68:69], v[44:45], v[216:217] op_sel:[1,1,0] op_sel_hi:[0,1,1] neg_lo:[1,0,0]
    v_pk_fma_f32 v[70:71], v[70:71], v[46:47], v[218:219] op_sel:[1,1,0] op_sel_hi:[0,1,1] neg_lo:[1,0,0]
    v_cvt_pk_bf16_f32 v84, v40, v41
    v_cvt_pk_bf16_f32 v85, v42, v43
    v_cvt_pk_bf16_f32 v86, v68, v69
    v_cvt_pk_bf16_f32 v87, v70, v71
    ds_write_b64 v4, v[84:85] offset:17952
    ds_write_b64 v4, v[86:87] offset:5280
    v_pk_mul_f32 v[36:37], v[40:41], v[48:49] op_sel:[0,0] op_sel_hi:[1,0]
    v_pk_mul_f32 v[38:39], v[42:43], v[50:51] op_sel:[0,0] op_sel_hi:[1,0]
    v_pk_mul_f32 v[216:217], v[68:69], v[44:45] op_sel:[0,0] op_sel_hi:[1,0]
    v_pk_mul_f32 v[218:219], v[70:71], v[46:47] op_sel:[0,0] op_sel_hi:[1,0]
    v_pk_fma_f32 v[40:41], v[40:41], v[48:49], v[36:37] op_sel:[1,1,0] op_sel_hi:[0,1,1] neg_lo:[1,0,0]
    v_pk_fma_f32 v[42:43], v[42:43], v[50:51], v[38:39] op_sel:[1,1,0] op_sel_hi:[0,1,1] neg_lo:[1,0,0]
    v_pk_fma_f32 v[68:69], v[68:69], v[44:45], v[216:217] op_sel:[1,1,0] op_sel_hi:[0,1,1] neg_lo:[1,0,0]
    v_pk_fma_f32 v[70:71], v[70:71], v[46:47], v[218:219] op_sel:[1,1,0] op_sel_hi:[0,1,1] neg_lo:[1,0,0]
    v_cvt_pk_bf16_f32 v80, v40, v41
    v_cvt_pk_bf16_f32 v81, v42, v43
    v_cvt_pk_bf16_f32 v82, v68, v69
    v_cvt_pk_bf16_f32 v83, v70, v71
    ds_write_b64 v4, v[80:81] offset:18480
    ds_write_b64 v4, v[82:83] offset:5808
    buffer_load_dwordx2 v[244:245], v7, s[8:11], s7 offen offset:2560
    v_pk_mul_f32 v[36:37], v[40:41], v[48:49] op_sel:[0,0] op_sel_hi:[1,0]
    v_pk_mul_f32 v[38:39], v[42:43], v[50:51] op_sel:[0,0] op_sel_hi:[1,0]
    v_pk_mul_f32 v[216:217], v[68:69], v[44:45] op_sel:[0,0] op_sel_hi:[1,0]
    v_pk_mul_f32 v[218:219], v[70:71], v[46:47] op_sel:[0,0] op_sel_hi:[1,0]
    v_pk_fma_f32 v[40:41], v[40:41], v[48:49], v[36:37] op_sel:[1,1,0] op_sel_hi:[0,1,1] neg_lo:[1,0,0]
    v_pk_fma_f32 v[42:43], v[42:43], v[50:51], v[38:39] op_sel:[1,1,0] op_sel_hi:[0,1,1] neg_lo:[1,0,0]
    v_pk_fma_f32 v[64:65], v[68:69], v[44:45], v[216:217] op_sel:[1,1,0] op_sel_hi:[0,1,1] neg_lo:[1,0,0]
    v_pk_fma_f32 v[66:67], v[70:71], v[46:47], v[218:219] op_sel:[1,1,0] op_sel_hi:[0,1,1] neg_lo:[1,0,0]
    v_cvt_pk_bf16_f32 v84, v40, v41
    v_cvt_pk_bf16_f32 v85, v42, v43
    v_cvt_pk_bf16_f32 v86, v64, v65
    v_cvt_pk_bf16_f32 v87, v66, v67
    ds_write_b64 v4, v[84:85] offset:19008
    ds_write_b64 v4, v[86:87] offset:6336
    v_pk_mul_f32 v[36:37], v[40:41], v[48:49] op_sel:[0,0] op_sel_hi:[1,0]
    v_pk_mul_f32 v[38:39], v[42:43], v[50:51] op_sel:[0,0] op_sel_hi:[1,0]
    v_pk_mul_f32 v[216:217], v[64:65], v[44:45] op_sel:[0,0] op_sel_hi:[1,0]
    v_pk_mul_f32 v[218:219], v[66:67], v[46:47] op_sel:[0,0] op_sel_hi:[1,0]
    v_pk_fma_f32 v[40:41], v[40:41], v[48:49], v[36:37] op_sel:[1,1,0] op_sel_hi:[0,1,1] neg_lo:[1,0,0]
    v_pk_fma_f32 v[42:43], v[42:43], v[50:51], v[38:39] op_sel:[1,1,0] op_sel_hi:[0,1,1] neg_lo:[1,0,0]
    v_pk_fma_f32 v[68:69], v[64:65], v[44:45], v[216:217] op_sel:[1,1,0] op_sel_hi:[0,1,1] neg_lo:[1,0,0]
    v_pk_fma_f32 v[70:71], v[66:67], v[46:47], v[218:219] op_sel:[1,1,0] op_sel_hi:[0,1,1] neg_lo:[1,0,0]
    v_cvt_pk_bf16_f32 v80, v40, v41
    v_cvt_pk_bf16_f32 v81, v42, v43
    v_cvt_pk_bf16_f32 v82, v68, v69
    v_cvt_pk_bf16_f32 v83, v70, v71
    ds_write_b64 v4, v[80:81] offset:19536
    ds_write_b64 v4, v[82:83] offset:6864
    v_pk_mul_f32 v[36:37], v[40:41], v[48:49] op_sel:[0,0] op_sel_hi:[1,0]
    v_pk_mul_f32 v[38:39], v[42:43], v[50:51] op_sel:[0,0] op_sel_hi:[1,0]
    v_pk_mul_f32 v[216:217], v[68:69], v[44:45] op_sel:[0,0] op_sel_hi:[1,0]
    v_pk_mul_f32 v[218:219], v[70:71], v[46:47] op_sel:[0,0] op_sel_hi:[1,0]
    v_pk_fma_f32 v[40:41], v[40:41], v[48:49], v[36:37] op_sel:[1,1,0] op_sel_hi:[0,1,1] neg_lo:[1,0,0]
    v_pk_fma_f32 v[42:43], v[42:43], v[50:51], v[38:39] op_sel:[1,1,0] op_sel_hi:[0,1,1] neg_lo:[1,0,0]
    v_pk_fma_f32 v[68:69], v[68:69], v[44:45], v[216:217] op_sel:[1,1,0] op_sel_hi:[0,1,1] neg_lo:[1,0,0]
    v_pk_fma_f32 v[70:71], v[70:71], v[46:47], v[218:219] op_sel:[1,1,0] op_sel_hi:[0,1,1] neg_lo:[1,0,0]
    v_cvt_pk_bf16_f32 v84, v40, v41
    v_cvt_pk_bf16_f32 v85, v42, v43
    v_cvt_pk_bf16_f32 v86, v68, v69
    v_cvt_pk_bf16_f32 v87, v70, v71
    ds_write_b64 v4, v[84:85] offset:20064
    ds_write_b64 v4, v[86:87] offset:7392
    v_pk_mul_f32 v[36:37], v[40:41], v[48:49] op_sel:[0,0] op_sel_hi:[1,0]
    v_pk_mul_f32 v[38:39], v[42:43], v[50:51] op_sel:[0,0] op_sel_hi:[1,0]
    v_pk_mul_f32 v[216:217], v[68:69], v[44:45] op_sel:[0,0] op_sel_hi:[1,0]
    v_pk_mul_f32 v[218:219], v[70:71], v[46:47] op_sel:[0,0] op_sel_hi:[1,0]
    v_pk_fma_f32 v[40:41], v[40:41], v[48:49], v[36:37] op_sel:[1,1,0] op_sel_hi:[0,1,1] neg_lo:[1,0,0]
    v_pk_fma_f32 v[42:43], v[42:43], v[50:51], v[38:39] op_sel:[1,1,0] op_sel_hi:[0,1,1] neg_lo:[1,0,0]
    v_pk_fma_f32 v[68:69], v[68:69], v[44:45], v[216:217] op_sel:[1,1,0] op_sel_hi:[0,1,1] neg_lo:[1,0,0]
    v_pk_fma_f32 v[70:71], v[70:71], v[46:47], v[218:219] op_sel:[1,1,0] op_sel_hi:[0,1,1] neg_lo:[1,0,0]
    v_cvt_pk_bf16_f32 v80, v40, v41
    v_cvt_pk_bf16_f32 v81, v42, v43
    v_cvt_pk_bf16_f32 v82, v68, v69
    v_cvt_pk_bf16_f32 v83, v70, v71
    ds_write_b64 v4, v[80:81] offset:20592
    ds_write_b64 v4, v[82:83] offset:7920
    buffer_load_dwordx2 v[246:247], v7, s[8:11], s7 offen offset:3840
    ds_read_b128 v[88:91], v5 offset:0
    ds_read_b128 v[92:95], v5 offset:16
    ds_read_b128 v[96:99], v5 offset:32
    ds_read_b128 v[100:103], v5 offset:48
    v_pk_mul_f32 v[36:37], v[40:41], v[48:49] op_sel:[0,0] op_sel_hi:[1,0]
    v_pk_mul_f32 v[38:39], v[42:43], v[50:51] op_sel:[0,0] op_sel_hi:[1,0]
    v_pk_fma_f32 v[40:41], v[40:41], v[48:49], v[36:37] op_sel:[1,1,0] op_sel_hi:[0,1,1] neg_lo:[1,0,0]
    v_pk_fma_f32 v[42:43], v[42:43], v[50:51], v[38:39] op_sel:[1,1,0] op_sel_hi:[0,1,1] neg_lo:[1,0,0]
    v_cvt_pk_bf16_f32 v84, v40, v41
    v_cvt_pk_bf16_f32 v85, v42, v43
    v_cvt_pk_bf16_f32 v86, v52, v53
    v_cvt_pk_bf16_f32 v87, v54, v55
    ds_write_b64 v4, v[84:85] offset:21120
    ds_write_b64 v4, v[86:87] offset:8448
    ds_read_b128 v[104:107], v5 offset:64
    ds_read_b128 v[108:111], v5 offset:80
    ds_read_b128 v[112:115], v5 offset:96
    ds_read_b128 v[116:119], v5 offset:112
    v_pk_mul_f32 v[36:37], v[40:41], v[48:49] op_sel:[0,0] op_sel_hi:[1,0]
    v_pk_mul_f32 v[38:39], v[42:43], v[50:51] op_sel:[0,0] op_sel_hi:[1,0]
    v_pk_mul_f32 v[216:217], v[52:53], v[56:57] op_sel:[0,0] op_sel_hi:[1,0]
    v_pk_mul_f32 v[218:219], v[54:55], v[58:59] op_sel:[0,0] op_sel_hi:[1,0]
    v_pk_fma_f32 v[40:41], v[40:41], v[48:49], v[36:37] op_sel:[1,1,0] op_sel_hi:[0,1,1] neg_lo:[1,0,0]
    v_pk_fma_f32 v[42:43], v[42:43], v[50:51], v[38:39] op_sel:[1,1,0] op_sel_hi:[0,1,1] neg_lo:[1,0,0]
    v_pk_fma_f32 v[68:69], v[52:53], v[56:57], v[216:217] op_sel:[1,1,0] op_sel_hi:[0,1,1] neg_lo:[1,0,0]
    v_pk_fma_f32 v[70:71], v[54:55], v[58:59], v[218:219] op_sel:[1,1,0] op_sel_hi:[0,1,1] neg_lo:[1,0,0]
    v_cvt_pk_bf16_f32 v80, v40, v41
    v_cvt_pk_bf16_f32 v81, v42, v43
    v_cvt_pk_bf16_f32 v82, v68, v69
    v_cvt_pk_bf16_f32 v83, v70, v71
    ds_write_b64 v4, v[80:81] offset:0
    ds_write_b64 v4, v[82:83] offset:8976
    ds_read_b128 v[152:155], v5 offset:13200
    ds_read_b128 v[156:159], v5 offset:13216
    v_pk_mul_f32 v[36:37], v[40:41], v[48:49] op_sel:[0,0] op_sel_hi:[1,0]
    v_pk_mul_f32 v[38:39], v[42:43], v[50:51] op_sel:[0,0] op_sel_hi:[1,0]
    v_pk_mul_f32 v[216:217], v[52:53], v[60:61] op_sel:[0,0] op_sel_hi:[1,0]
    v_pk_mul_f32 v[218:219], v[54:55], v[62:63] op_sel:[0,0] op_sel_hi:[1,0]
    v_pk_fma_f32 v[40:41], v[40:41], v[48:49], v[36:37] op_sel:[1,1,0] op_sel_hi:[0,1,1] neg_lo:[1,0,0]
    v_pk_fma_f32 v[42:43], v[42:43], v[50:51], v[38:39] op_sel:[1,1,0] op_sel_hi:[0,1,1] neg_lo:[1,0,0]
    v_pk_fma_f32 v[68:69], v[52:53], v[60:61], v[216:217] op_sel:[1,1,0] op_sel_hi:[0,1,1] neg_lo:[1,0,0]
    v_pk_fma_f32 v[70:71], v[54:55], v[62:63], v[218:219] op_sel:[1,1,0] op_sel_hi:[0,1,1] neg_lo:[1,0,0]
    v_cvt_pk_bf16_f32 v84, v40, v41
    v_cvt_pk_bf16_f32 v85, v42, v43
    v_cvt_pk_bf16_f32 v86, v68, v69
    v_cvt_pk_bf16_f32 v87, v70, v71
    ds_write_b64 v4, v[84:85] offset:528
    ds_write_b64 v4, v[86:87] offset:9504
    ds_read_b128 v[160:163], v5 offset:13232
    ds_read_b128 v[164:167], v5 offset:13248
    v_pk_mul_f32 v[36:37], v[40:41], v[48:49] op_sel:[0,0] op_sel_hi:[1,0]
    v_pk_mul_f32 v[38:39], v[42:43], v[50:51] op_sel:[0,0] op_sel_hi:[1,0]
    v_pk_mul_f32 v[216:217], v[52:53], v[64:65] op_sel:[0,0] op_sel_hi:[1,0]
    v_pk_mul_f32 v[218:219], v[54:55], v[66:67] op_sel:[0,0] op_sel_hi:[1,0]
    v_pk_fma_f32 v[40:41], v[40:41], v[48:49], v[36:37] op_sel:[1,1,0] op_sel_hi:[0,1,1] neg_lo:[1,0,0]
    v_pk_fma_f32 v[42:43], v[42:43], v[50:51], v[38:39] op_sel:[1,1,0] op_sel_hi:[0,1,1] neg_lo:[1,0,0]
    v_pk_fma_f32 v[68:69], v[52:53], v[64:65], v[216:217] op_sel:[1,1,0] op_sel_hi:[0,1,1] neg_lo:[1,0,0]
    v_pk_fma_f32 v[70:71], v[54:55], v[66:67], v[218:219] op_sel:[1,1,0] op_sel_hi:[0,1,1] neg_lo:[1,0,0]
    v_cvt_pk_bf16_f32 v80, v40, v41
    v_cvt_pk_bf16_f32 v81, v42, v43
    v_cvt_pk_bf16_f32 v82, v68, v69
    v_cvt_pk_bf16_f32 v83, v70, v71
    ds_write_b64 v4, v[80:81] offset:1056
    ds_write_b64 v4, v[82:83] offset:10032
    ds_read_b128 v[168:171], v5 offset:13264
    ds_read_b128 v[172:175], v5 offset:13280
    v_pk_mul_f32 v[36:37], v[40:41], v[48:49] op_sel:[0,0] op_sel_hi:[1,0]
    v_pk_mul_f32 v[38:39], v[42:43], v[50:51] op_sel:[0,0] op_sel_hi:[1,0]
    v_pk_mul_f32 v[216:217], v[52:53], v[52:53] op_sel:[0,0] op_sel_hi:[1,0]
    v_pk_mul_f32 v[218:219], v[54:55], v[54:55] op_sel:[0,0] op_sel_hi:[1,0]
    v_pk_fma_f32 v[40:41], v[40:41], v[48:49], v[36:37] op_sel:[1,1,0] op_sel_hi:[0,1,1] neg_lo:[1,0,0]
    v_pk_fma_f32 v[42:43], v[42:43], v[50:51], v[38:39] op_sel:[1,1,0] op_sel_hi:[0,1,1] neg_lo:[1,0,0]
    v_pk_fma_f32 v[72:73], v[52:53], v[52:53], v[216:217] op_sel:[1,1,0] op_sel_hi:[0,1,1] neg_lo:[1,0,0]
    v_pk_fma_f32 v[74:75], v[54:55], v[54:55], v[218:219] op_sel:[1,1,0] op_sel_hi:[0,1,1] neg_lo:[1,0,0]
    v_cvt_pk_bf16_f32 v84, v40, v41
    v_cvt_pk_bf16_f32 v85, v42, v43
    v_cvt_pk_bf16_f32 v86, v72, v73
    v_cvt_pk_bf16_f32 v87, v74, v75
    ds_write_b64 v4, v[84:85] offset:1584
    ds_write_b64 v4, v[86:87] offset:10560
    ds_read_b128 v[176:179], v5 offset:13296
    ds_read_b128 v[180:183], v5 offset:13312
    v_pk_mul_f32 v[36:37], v[40:41], v[48:49] op_sel:[0,0] op_sel_hi:[1,0]
    v_pk_mul_f32 v[38:39], v[42:43], v[50:51] op_sel:[0,0] op_sel_hi:[1,0]
    v_pk_mul_f32 v[216:217], v[72:73], v[60:61] op_sel:[0,0] op_sel_hi:[1,0]
    v_pk_mul_f32 v[218:219], v[74:75], v[62:63] op_sel:[0,0] op_sel_hi:[1,0]
    v_pk_fma_f32 v[40:41], v[40:41], v[48:49], v[36:37] op_sel:[1,1,0] op_sel_hi:[0,1,1] neg_lo:[1,0,0]
    v_pk_fma_f32 v[42:43], v[42:43], v[50:51], v[38:39] op_sel:[1,1,0] op_sel_hi:[0,1,1] neg_lo:[1,0,0]
    v_pk_fma_f32 v[68:69], v[72:73], v[60:61], v[216:217] op_sel:[1,1,0] op_sel_hi:[0,1,1] neg_lo:[1,0,0]
    v_pk_fma_f32 v[70:71], v[74:75], v[62:63], v[218:219] op_sel:[1,1,0] op_sel_hi:[0,1,1] neg_lo:[1,0,0]
    v_cvt_pk_bf16_f32 v80, v40, v41
    v_cvt_pk_bf16_f32 v81, v42, v43
    v_cvt_pk_bf16_f32 v82, v68, v69
    v_cvt_pk_bf16_f32 v83, v70, v71
    ds_write_b64 v4, v[80:81] offset:2112
    ds_write_b64 v4, v[82:83] offset:11088
    v_pk_mul_f32 v[36:37], v[40:41], v[48:49] op_sel:[0,0] op_sel_hi:[1,0]
    v_pk_mul_f32 v[38:39], v[42:43], v[50:51] op_sel:[0,0] op_sel_hi:[1,0]
    v_pk_mul_f32 v[216:217], v[72:73], v[52:53] op_sel:[0,0] op_sel_hi:[1,0]
    v_pk_mul_f32 v[218:219], v[74:75], v[54:55] op_sel:[0,0] op_sel_hi:[1,0]
    v_pk_fma_f32 v[40:41], v[40:41], v[48:49], v[36:37] op_sel:[1,1,0] op_sel_hi:[0,1,1] neg_lo:[1,0,0]
    v_pk_fma_f32 v[42:43], v[42:43], v[50:51], v[38:39] op_sel:[1,1,0] op_sel_hi:[0,1,1] neg_lo:[1,0,0]
    v_pk_fma_f32 v[76:77], v[72:73], v[52:53], v[216:217] op_sel:[1,1,0] op_sel_hi:[0,1,1] neg_lo:[1,0,0]
    v_pk_fma_f32 v[78:79], v[74:75], v[54:55], v[218:219] op_sel:[1,1,0] op_sel_hi:[0,1,1] neg_lo:[1,0,0]
    v_cvt_pk_bf16_f32 v84, v40, v41
    v_cvt_pk_bf16_f32 v85, v42, v43
    v_cvt_pk_bf16_f32 v86, v76, v77
    v_cvt_pk_bf16_f32 v87, v78, v79
    ds_write_b64 v4, v[84:85] offset:2640
    ds_write_b64 v4, v[86:87] offset:11616
    v_pk_mul_f32 v[36:37], v[40:41], v[48:49] op_sel:[0,0] op_sel_hi:[1,0]
    v_pk_mul_f32 v[38:39], v[42:43], v[50:51] op_sel:[0,0] op_sel_hi:[1,0]
    v_pk_mul_f32 v[216:217], v[76:77], v[60:61] op_sel:[0,0] op_sel_hi:[1,0]
    v_pk_mul_f32 v[218:219], v[78:79], v[62:63] op_sel:[0,0] op_sel_hi:[1,0]
    v_pk_fma_f32 v[40:41], v[40:41], v[48:49], v[36:37] op_sel:[1,1,0] op_sel_hi:[0,1,1] neg_lo:[1,0,0]
    v_pk_fma_f32 v[42:43], v[42:43], v[50:51], v[38:39] op_sel:[1,1,0] op_sel_hi:[0,1,1] neg_lo:[1,0,0]
    v_pk_fma_f32 v[68:69], v[76:77], v[60:61], v[216:217] op_sel:[1,1,0] op_sel_hi:[0,1,1] neg_lo:[1,0,0]
    v_pk_fma_f32 v[70:71], v[78:79], v[62:63], v[218:219] op_sel:[1,1,0] op_sel_hi:[0,1,1] neg_lo:[1,0,0]
    v_cvt_pk_bf16_f32 v80, v40, v41
    v_cvt_pk_bf16_f32 v81, v42, v43
    v_cvt_pk_bf16_f32 v82, v68, v69
    v_cvt_pk_bf16_f32 v83, v70, v71
    ds_write_b64 v4, v[80:81] offset:3168
    ds_write_b64 v4, v[82:83] offset:12144
    v_pk_mul_f32 v[36:37], v[40:41], v[48:49] op_sel:[0,0] op_sel_hi:[1,0]
    v_pk_mul_f32 v[38:39], v[42:43], v[50:51] op_sel:[0,0] op_sel_hi:[1,0]
    v_pk_mul_f32 v[216:217], v[72:73], v[72:73] op_sel:[0,0] op_sel_hi:[1,0]
    v_pk_mul_f32 v[218:219], v[74:75], v[74:75] op_sel:[0,0] op_sel_hi:[1,0]
    v_pk_fma_f32 v[40:41], v[40:41], v[48:49], v[36:37] op_sel:[1,1,0] op_sel_hi:[0,1,1] neg_lo:[1,0,0]
    v_pk_fma_f32 v[42:43], v[42:43], v[50:51], v[38:39] op_sel:[1,1,0] op_sel_hi:[0,1,1] neg_lo:[1,0,0]
    v_pk_fma_f32 v[68:69], v[72:73], v[72:73], v[216:217] op_sel:[1,1,0] op_sel_hi:[0,1,1] neg_lo:[1,0,0]
    v_pk_fma_f32 v[70:71], v[74:75], v[74:75], v[218:219] op_sel:[1,1,0] op_sel_hi:[0,1,1] neg_lo:[1,0,0]
    v_cvt_pk_bf16_f32 v84, v40, v41
    v_cvt_pk_bf16_f32 v85, v42, v43
    v_cvt_pk_bf16_f32 v86, v68, v69
    v_cvt_pk_bf16_f32 v87, v70, v71
    ds_write_b64 v4, v[84:85] offset:3696
    ds_write_b64 v4, v[86:87] offset:12672
    ds_read_b128 v[120:123], v6 offset:8448
    ds_read_b128 v[124:127], v6 offset:8464
    v_pk_mul_f32 v[36:37], v[40:41], v[48:49] op_sel:[0,0] op_sel_hi:[1,0]
    v_pk_mul_f32 v[38:39], v[42:43], v[50:51] op_sel:[0,0] op_sel_hi:[1,0]
    v_pk_fma_f32 v[40:41], v[40:41], v[48:49], v[36:37] op_sel:[1,1,0] op_sel_hi:[0,1,1] neg_lo:[1,0,0]
    v_pk_fma_f32 v[42:43], v[42:43], v[50:51], v[38:39] op_sel:[1,1,0] op_sel_hi:[0,1,1] neg_lo:[1,0,0]
    v_cvt_pk_bf16_f32 v80, v40, v41
    v_cvt_pk_bf16_f32 v81, v42, v43
    ds_write_b64 v4, v[80:81] offset:4224
    ds_read_b128 v[128:131], v6 offset:8480
    ds_read_b128 v[132:135], v6 offset:8496
    v_pk_mul_f32 v[36:37], v[40:41], v[48:49] op_sel:[0,0] op_sel_hi:[1,0]
    v_pk_mul_f32 v[38:39], v[42:43], v[50:51] op_sel:[0,0] op_sel_hi:[1,0]
    v_pk_fma_f32 v[40:41], v[40:41], v[48:49], v[36:37] op_sel:[1,1,0] op_sel_hi:[0,1,1] neg_lo:[1,0,0]
    v_pk_fma_f32 v[42:43], v[42:43], v[50:51], v[38:39] op_sel:[1,1,0] op_sel_hi:[0,1,1] neg_lo:[1,0,0]
    v_cvt_pk_bf16_f32 v82, v40, v41
    v_cvt_pk_bf16_f32 v83, v42, v43
    ds_write_b64 v4, v[82:83] offset:4752
    ds_read_b128 v[136:139], v6 offset:8512
    ds_read_b128 v[140:143], v6 offset:8528
    v_pk_mul_f32 v[36:37], v[40:41], v[48:49] op_sel:[0,0] op_sel_hi:[1,0]
    v_pk_mul_f32 v[38:39], v[42:43], v[50:51] op_sel:[0,0] op_sel_hi:[1,0]
    v_pk_fma_f32 v[40:41], v[40:41], v[48:49], v[36:37] op_sel:[1,1,0] op_sel_hi:[0,1,1] neg_lo:[1,0,0]
    v_pk_fma_f32 v[42:43], v[42:43], v[50:51], v[38:39] op_sel:[1,1,0] op_sel_hi:[0,1,1] neg_lo:[1,0,0]
    v_cvt_pk_bf16_f32 v84, v40, v41
    v_cvt_pk_bf16_f32 v85, v42, v43
    ds_write_b64 v4, v[84:85] offset:5280
    ds_read_b128 v[144:147], v6 offset:8544
    ds_read_b128 v[148:151], v6 offset:8560
    v_pk_mul_f32 v[36:37], v[40:41], v[48:49] op_sel:[0,0] op_sel_hi:[1,0]
    v_pk_mul_f32 v[38:39], v[42:43], v[50:51] op_sel:[0,0] op_sel_hi:[1,0]
    v_pk_fma_f32 v[40:41], v[40:41], v[48:49], v[36:37] op_sel:[1,1,0] op_sel_hi:[0,1,1] neg_lo:[1,0,0]
    v_pk_fma_f32 v[42:43], v[42:43], v[50:51], v[38:39] op_sel:[1,1,0] op_sel_hi:[0,1,1] neg_lo:[1,0,0]
    v_cvt_pk_bf16_f32 v86, v40, v41
    v_cvt_pk_bf16_f32 v87, v42, v43
    ds_write_b64 v4, v[86:87] offset:5808
    v_pk_mul_f32 v[36:37], v[40:41], v[48:49] op_sel:[0,0] op_sel_hi:[1,0]
    v_pk_mul_f32 v[38:39], v[42:43], v[50:51] op_sel:[0,0] op_sel_hi:[1,0]
    v_pk_fma_f32 v[40:41], v[40:41], v[48:49], v[36:37] op_sel:[1,1,0] op_sel_hi:[0,1,1] neg_lo:[1,0,0]
    v_pk_fma_f32 v[42:43], v[42:43], v[50:51], v[38:39] op_sel:[1,1,0] op_sel_hi:[0,1,1] neg_lo:[1,0,0]
    v_cvt_pk_bf16_f32 v80, v40, v41
    v_cvt_pk_bf16_f32 v81, v42, v43
    ds_write_b64 v4, v[80:81] offset:6336
    v_pk_mul_f32 v[36:37], v[40:41], v[48:49] op_sel:[0,0] op_sel_hi:[1,0]
    v_pk_mul_f32 v[38:39], v[42:43], v[50:51] op_sel:[0,0] op_sel_hi:[1,0]
    v_pk_fma_f32 v[40:41], v[40:41], v[48:49], v[36:37] op_sel:[1,1,0] op_sel_hi:[0,1,1] neg_lo:[1,0,0]
    v_pk_fma_f32 v[42:43], v[42:43], v[50:51], v[38:39] op_sel:[1,1,0] op_sel_hi:[0,1,1] neg_lo:[1,0,0]
    v_cvt_pk_bf16_f32 v82, v40, v41
    v_cvt_pk_bf16_f32 v83, v42, v43
    ds_write_b64 v4, v[82:83] offset:6864
    v_pk_mul_f32 v[36:37], v[40:41], v[48:49] op_sel:[0,0] op_sel_hi:[1,0]
    v_pk_mul_f32 v[38:39], v[42:43], v[50:51] op_sel:[0,0] op_sel_hi:[1,0]
    v_pk_fma_f32 v[40:41], v[40:41], v[48:49], v[36:37] op_sel:[1,1,0] op_sel_hi:[0,1,1] neg_lo:[1,0,0]
    v_pk_fma_f32 v[42:43], v[42:43], v[50:51], v[38:39] op_sel:[1,1,0] op_sel_hi:[0,1,1] neg_lo:[1,0,0]
    v_cvt_pk_bf16_f32 v84, v40, v41
    v_cvt_pk_bf16_f32 v85, v42, v43
    ds_write_b64 v4, v[84:85] offset:7392
    v_pk_mul_f32 v[36:37], v[40:41], v[48:49] op_sel:[0,0] op_sel_hi:[1,0]
    v_pk_mul_f32 v[38:39], v[42:43], v[50:51] op_sel:[0,0] op_sel_hi:[1,0]
    v_pk_fma_f32 v[40:41], v[40:41], v[48:49], v[36:37] op_sel:[1,1,0] op_sel_hi:[0,1,1] neg_lo:[1,0,0]
    v_pk_fma_f32 v[42:43], v[42:43], v[50:51], v[38:39] op_sel:[1,1,0] op_sel_hi:[0,1,1] neg_lo:[1,0,0]
    v_cvt_pk_bf16_f32 v86, v40, v41
    v_cvt_pk_bf16_f32 v87, v42, v43
    ds_write_b64 v4, v[86:87] offset:7920
    ds_read_b128 v[184:187], v5 offset:0
    ds_read_b128 v[188:191], v5 offset:16
    ds_read_b128 v[192:195], v5 offset:32
    ds_read_b128 v[196:199], v5 offset:48
    ds_read_b128 v[200:203], v5 offset:64
    ds_read_b128 v[204:207], v5 offset:80
    ds_read_b128 v[208:211], v5 offset:96
    ds_read_b128 v[212:215], v5 offset:112
    v_lshlrev_b32 v2, 6, v0
    v_mov_b32 v3, 0
    v_lshlrev_b32 v32, 16, v15
    v_cmp_eq_u32 vcc, 0, v1
    s_nop 1
    v_cndmask_b32 v32, 0, v32, vcc
    v_mov_b32 v33, 0
    v_mov_b32 v34, s56
    s_waitcnt lgkmcnt(8)
    s_nop 0
    v_mfma_f32_16x16x32_bf16 v[8:11], v[88:91], v[152:155], 0
    v_mfma_f32_16x16x32_bf16 v[16:19], v[120:123], v[152:155], 0
    v_mfma_f32_16x16x32_bf16 v[8:11], v[92:95], v[156:159], v[8:11]
    v_mfma_f32_16x16x32_bf16 v[16:19], v[124:127], v[156:159], v[16:19]
    v_mfma_f32_16x16x32_bf16 v[8:11], v[96:99], v[160:163], v[8:11]
    v_mfma_f32_16x16x32_bf16 v[16:19], v[128:131], v[160:163], v[16:19]
    v_mfma_f32_16x16x32_bf16 v[8:11], v[100:103], v[164:167], v[8:11]
    v_mfma_f32_16x16x32_bf16 v[16:19], v[132:135], v[164:167], v[16:19]
    v_mfma_f32_16x16x32_bf16 v[8:11], v[104:107], v[168:171], v[8:11]
    v_mfma_f32_16x16x32_bf16 v[16:19], v[136:139], v[168:171], v[16:19]
    v_mfma_f32_16x16x32_bf16 v[8:11], v[108:111], v[172:175], v[8:11]
    v_mfma_f32_16x16x32_bf16 v[16:19], v[140:143], v[172:175], v[16:19]
    v_mfma_f32_16x16x32_bf16 v[8:11], v[112:115], v[176:179], v[8:11]
    v_mfma_f32_16x16x32_bf16 v[16:19], v[144:147], v[176:179], v[16:19]
    v_mfma_f32_16x16x32_bf16 v[8:11], v[116:119], v[180:183], v[8:11]
    v_mfma_f32_16x16x32_bf16 v[16:19], v[148:151], v[180:183], v[16:19]
    s_waitcnt lgkmcnt(0)
    s_nop 0
    v_mfma_f32_16x16x32_bf16 v[12:15], v[88:91], v[184:187], 0
    v_mfma_f32_16x16x32_bf16 v[20:23], v[120:123], v[184:187], 0
    v_mfma_f32_16x16x32_bf16 v[12:15], v[92:95], v[188:191], v[12:15]
    v_mfma_f32_16x16x32_bf16 v[20:23], v[124:127], v[188:191], v[20:23]
    v_mfma_f32_16x16x32_bf16 v[12:15], v[96:99], v[192:195], v[12:15]
    v_mfma_f32_16x16x32_bf16 v[20:23], v[128:131], v[192:195], v[20:23]
    v_mfma_f32_16x16x32_bf16 v[12:15], v[100:103], v[196:199], v[12:15]
    v_mfma_f32_16x16x32_bf16 v[20:23], v[132:135], v[196:199], v[20:23]
    v_mfma_f32_16x16x32_bf16 v[12:15], v[104:107], v[200:203], v[12:15]
    v_mfma_f32_16x16x32_bf16 v[20:23], v[136:139], v[200:203], v[20:23]
    v_add_f32 v8, v8, v32
    v_subrev_u32 v38, 4, v34
    ds_write_b32 v38, v33
    ds_write_b128 v224, v[8:11]
    ds_write_b64 v226, v[16:17] offset:1536
    ds_write_b64 v227, v[18:19] offset:1536
    v_mfma_f32_16x16x32_bf16 v[12:15], v[108:111], v[204:207], v[12:15]
    v_mfma_f32_16x16x32_bf16 v[20:23], v[140:143], v[204:207], v[20:23]
    v_mfma_f32_16x16x32_bf16 v[12:15], v[112:115], v[208:211], v[12:15]
    v_mfma_f32_16x16x32_bf16 v[20:23], v[144:147], v[208:211], v[20:23]
    v_mfma_f32_16x16x32_bf16 v[12:15], v[116:119], v[212:215], v[12:15]
    v_mfma_f32_16x16x32_bf16 v[20:23], v[148:151], v[212:215], v[20:23]
    v_lshl_add_u32 v35, v1, 4, s56
    v_lshl_add_u32 v36, v1, 3, s56
    v_add_u32 v37, 2048, v36
    v_subrev_u32_e64 v38, 4, v35
    v_lshl_add_u32 v60, v1, 4, s59
    v_lshl_add_u32 v61, v1, 5, s59
    v_lshl_add_u32 v62, v1, 6, s59
    ds_read_b128 v[40:43], v35
    ds_read_b32 v44, v38
    ds_write2_b32 v225, v12, v14 offset0:0 offset1:1
    ds_write_b64 v228, v[20:21] offset:1536
    ds_write_b64 v229, v[22:23] offset:1536
    ds_read2_b64 v[48:51], v36 offset0:128 offset1:129
    ds_read_b32 v45, v34 offset:1020
    ds_read2_b64 v[52:55], v36 offset0:192 offset1:193
    ds_read2_b64 v[56:59], v37 offset0:0 offset1:1
    s_waitcnt lgkmcnt(7)
    s_nop 0
    v_cvt_pk_bf16_f32 v88, v40, v44
    v_cvt_pk_bf16_f32 v89, v41, v40
    v_cvt_pk_bf16_f32 v90, v42, v41
    v_cvt_pk_bf16_f32 v91, v43, v42
    ds_write_b128 v60, v[88:91] offset:64
    s_waitcnt lgkmcnt(3)
    v_cndmask_b32 v45, v48, v45, vcc
    v_cvt_pk_bf16_f32 v93, v48, v48
    v_cvt_pk_bf16_f32 v94, v49, v48
    v_cvt_pk_bf16_f32 v95, v50, v49
    v_cvt_pk_bf16_f32 v92, v48, v45
    ds_write_b128 v60, v[92:95] offset:1088
    s_waitcnt lgkmcnt(3)
    s_nop 0
    v_cvt_pk_bf16_f32 v96, v52, v52
    v_cvt_pk_bf16_f32 v97, v52, v52
    v_cvt_pk_bf16_f32 v98, v52, v52
    v_cvt_pk_bf16_f32 v99, v53, v52
    v_cvt_pk_bf16_f32 v100, v53, v53
    v_cvt_pk_bf16_f32 v101, v53, v53
    v_cvt_pk_bf16_f32 v102, v54, v53
    v_cvt_pk_bf16_f32 v103, v54, v54
    ds_write_b128 v61, v[96:99] offset:2112
    ds_write_b128 v61, v[100:103] offset:2128
    s_waitcnt lgkmcnt(4)
    s_nop 0
    v_cvt_pk_bf16_f32 v104, v56, v56
    v_cvt_pk_bf16_f32 v105, v56, v56
    v_cvt_pk_bf16_f32 v106, v56, v56
    v_cvt_pk_bf16_f32 v107, v56, v56
    ds_write_b128 v62, v[104:107] offset:4160
    v_cvt_pk_bf16_f32 v108, v56, v56
    v_cvt_pk_bf16_f32 v109, v57, v56
    v_cvt_pk_bf16_f32 v110, v57, v57
    v_cvt_pk_bf16_f32 v111, v57, v57
    ds_write_b128 v62, v[108:111] offset:4176
    v_cvt_pk_bf16_f32 v112, v57, v57
    v_cvt_pk_bf16_f32 v113, v57, v57
    v_cvt_pk_bf16_f32 v114, v57, v57
    v_cvt_pk_bf16_f32 v115, v57, v57
    ds_write_b128 v62, v[112:115] offset:4192
    v_cvt_pk_bf16_f32 v116, v58, v57
    v_cvt_pk_bf16_f32 v117, v58, v58
    v_cvt_pk_bf16_f32 v118, v58, v58
    v_cvt_pk_bf16_f32 v119, v58, v58
    ds_write_b128 v62, v[116:119] offset:4208
    buffer_load_dwordx4 v[64:67], v2, s[64:67], 0 offen offset:0 sc1
    buffer_load_dwordx4 v[68:71], v2, s[64:67], 0 offen offset:16 sc1
    buffer_load_dwordx4 v[72:75], v2, s[64:67], 0 offen offset:32 sc1
    buffer_load_dwordx4 v[76:79], v2, s[64:67], 0 offen offset:48 sc1
    buffer_load_dword v24, v3, s[68:71], 0 offen sc1
    v_mov_b32 v31, v231
    v_mov_b32 v25, 0
    s_mul_i32 s5, s3, 4608
    s_add_u32 s5, s5, 126208
    v_lshl_add_u32 v26, v1, 2, s5
    ds_write_b32 v26, v25
    ds_write_b32 v26, v25 offset:2304
    v_and_b32 v27, 15, v1
    v_lshrrev_b32 v28, 4, v1
    v_lshl_add_u32 v29, v27, 2, s59
    ds_write_b32 v29, v25
    v_lshl_add_u32 v32, v1, 2, s59
    v_add_u32 v33, 1024, v32
    v_add_u32 v34, 2048, v32
    v_add_u32 v35, 3072, v32
    v_add_u32 v36, 4096, v32
    v_add_u32 v37, 5120, v32
    v_add_u32 v38, 6144, v32
    v_add_u32 v39, 7168, v32
    v_sub_u32 v40, v27, v28
    v_add_u32 v40, 3, v40
    v_lshl_add_u32 v40, v40, 4, s5
    s_mov_b32 s46, 0x05040100
    s_mov_b32 s47, 0x07060302
    s_waitcnt vmcnt(5)
    s_nop 0
    v_perm_b32 v48, v234, v232, s46
    v_perm_b32 v49, v238, v236, s46
    v_perm_b32 v50, v242, v240, s46
    v_perm_b32 v51, v246, v244, s46
    v_perm_b32 v52, v234, v232, s47
    v_perm_b32 v53, v238, v236, s47
    v_perm_b32 v54, v242, v240, s47
    v_perm_b32 v55, v246, v244, s47
    v_perm_b32 v56, v235, v233, s46
    v_perm_b32 v57, v239, v237, s46
    v_perm_b32 v58, v243, v241, s46
    v_perm_b32 v59, v247, v245, s46
    v_perm_b32 v60, v235, v233, s47
    v_perm_b32 v61, v239, v237, s47
    v_perm_b32 v62, v243, v241, s47
    v_perm_b32 v63, v247, v245, s47
    v_lshlrev_b32_e64 v41, 4, v0
    v_add_u32 v41, 147200, v41
    ds_write_b128 v41, v[48:51] offset:0
    ds_write_b128 v41, v[52:55] offset:4160
    ds_write_b128 v41, v[56:59] offset:8320
    ds_write_b128 v41, v[60:63] offset:12480
    v_lshlrev_b32 v176, 16, v48
    v_and_b32 v177, 0xffff0000, v48
    v_lshlrev_b32 v178, 16, v49
    v_and_b32 v179, 0xffff0000, v49
    v_lshlrev_b32 v180, 16, v50
    v_and_b32 v181, 0xffff0000, v50
    v_lshlrev_b32 v182, 16, v51
    v_and_b32 v183, 0xffff0000, v51
    v_lshlrev_b32 v184, 16, v52
    v_and_b32 v185, 0xffff0000, v52
    v_lshlrev_b32 v186, 16, v53
    v_and_b32 v187, 0xffff0000, v53
    v_lshlrev_b32 v188, 16, v54
    v_and_b32 v189, 0xffff0000, v54
    v_lshlrev_b32 v190, 16, v55
    v_and_b32 v191, 0xffff0000, v55
    v_lshlrev_b32 v192, 16, v56
    v_and_b32 v193, 0xffff0000, v56
    v_lshlrev_b32 v194, 16, v57
    v_and_b32 v195, 0xffff0000, v57
    v_lshlrev_b32 v196, 16, v58
    v_and_b32 v197, 0xffff0000, v58
    v_lshlrev_b32 v198, 16, v59
    v_and_b32 v199, 0xffff0000, v59
    v_lshlrev_b32 v200, 16, v60
    v_and_b32 v201, 0xffff0000, v60
    v_lshlrev_b32 v202, 16, v61
    v_and_b32 v203, 0xffff0000, v61
    v_lshlrev_b32 v204, 16, v62
    v_and_b32 v205, 0xffff0000, v62
    v_lshlrev_b32 v206, 16, v63
    v_and_b32 v207, 0xffff0000, v63
    v_and_b32 v42, 1, v0
    v_mul_u32_u24 v42, 2304, v42
    v_lshrrev_b32 v43, 1, v0
    v_lshl_add_u32 v42, v43, 4, v42
    v_add_u32 v42, 126464, v42
    v_mul_u32_u24 v255, 40960, v28
    v_lshl_add_u32 v255, v27, 4, v255
    s_add_u32 s12, s44, 0x700000
    s_addc_u32 s13, s45, 0
    s_nop 0
    s_mov_b32 s14, 0x280000
    s_mov_b32 s15, 0x20000
    s_mul_i32 s58, s3, 655360
    s_lshl_b32 s57, s60, 8
    s_add_u32 s58, s58, s57
    v_mov_b32 v212, -1
    v_mov_b32 v213, -1
    v_mov_b32 v214, -1
    v_mov_b32 v215, -1
    s_mul_i32 s6, s3, 4160
    s_add_u32 s6, s6, 147200
    v_lshlrev_b32 v44, 5, v27
    v_lshl_add_u32 v44, v28, 3, v44
    v_add_u32 v44, s6, v44
    v_min_u32 v45, 95, v1
    v_lshlrev_b32 v45, 7, v45
    v_add_u32 v46, 64, v1
    v_min_u32 v46, 95, v46
    v_lshlrev_b32 v46, 7, v46
    s_and_b32 s6, s2, 7
    s_lshl_b32 s6, s6, 4
    s_add_u32 s6, s6, s2
    s_bfe_u32 s6, s6, 0x40003
    s_mul_i32 s6, s6, 216
    s_and_b32 s75, s6, 15
    s_sub_u32 s6, s6, s75
    s_add_u32 s52, s36, s6
    s_addc_u32 s53, s37, 0
    s_sub_u32 s54, 2211840, s6
    s_mov_b32 s55, 0x20000
    s_lshl_b32 s74, s3, 10
    s_nop 0
    s_mov_b32 s62, 16384
    s_bfe_u32 s7, s2, 0x30004
    s_mul_i32 s7, s7, 276480
    s_add_u32 s20, s44, s7
    s_addc_u32 s21, s45, 0
    s_add_u32 s20, s20, 0x100000
    s_addc_u32 s21, s21, 0
    s_mov_b32 s22, 0x43800
    s_mov_b32 s23, 0x20000
    v_lshlrev_b32 v29, 4, v1
    s_mul_i32 s18, s3, 5120
    v_bfe_u32 v47, v1, 2, 2
    v_mul_u32_u24 v47, 4160, v47
    v_lshl_add_u32 v47, v28, 6, v47
    v_and_b32 v30, 3, v1
    v_lshl_add_u32 v47, v30, 3, v47
    s_lshl_b32 s6, s3, 10
    s_add_u32 s6, s6, 147200
    v_add_u32_e64 v47, s6, v47
    ds_read2_b32 v[112:113], v32 offset0:8 offset1:6
    ds_read2_b32 v[114:115], v32 offset0:4 offset1:2
    ds_read2_b32 v[116:117], v33 offset0:8 offset1:6
    ds_read2_b32 v[118:119], v33 offset0:4 offset1:2
    ds_read2_b32 v[120:121], v34 offset0:8 offset1:6
    ds_read2_b32 v[122:123], v34 offset0:4 offset1:2
    ds_read2_b32 v[124:125], v35 offset0:8 offset1:6
    ds_read2_b32 v[126:127], v35 offset0:4 offset1:2
    ds_read2_b32 v[128:129], v36 offset0:8 offset1:6
    ds_read2_b32 v[130:131], v36 offset0:4 offset1:2
    ds_read2_b32 v[132:133], v37 offset0:8 offset1:6
    ds_read2_b32 v[134:135], v37 offset0:4 offset1:2
    ds_read2_b32 v[136:137], v38 offset0:8 offset1:6
    ds_read2_b32 v[138:139], v38 offset0:4 offset1:2
    ds_read2_b32 v[140:141], v39 offset0:8 offset1:6
    ds_read2_b32 v[142:143], v39 offset0:4 offset1:2
    s_branch Lstf_2
Lst_1:
    s_nop 0
    buffer_load_dwordx4 v[64:67], v2, s[64:67], 0 offen offset:0 sc1
    buffer_load_dwordx4 v[68:71], v2, s[64:67], 0 offen offset:16 sc1
    buffer_load_dwordx4 v[72:75], v2, s[64:67], 0 offen offset:32 sc1
    buffer_load_dwordx4 v[76:79], v2, s[64:67], 0 offen offset:48 sc1
    buffer_load_dword v24, v3, s[68:71], 0 offen sc1
Lstf_2:
    s_waitcnt vmcnt(0)
    v_readfirstlane_b32 s72, v24
    v_min3_u32 v25, v65, v67, v69
    v_max3_u32 v26, v65, v67, v69
    v_min3_u32 v25, v25, v71, v73
    v_max3_u32 v26, v26, v71, v73
    v_min3_u32 v25, v25, v75, v77
    v_max3_u32 v26, v26, v75, v77
    v_min3_u32 v25, v25, v79, v24
    v_max3_u32 v26, v26, v79, v24
    v_max_u32 v26, 1, v26
    v_cmp_ne_u32 vcc, v25, v26
    s_sub_u32 s73, s73, 1
    s_cmp_lt_i32 s73, 0
    s_cbranch_scc1 Lto_3
    s_cbranch_vccnz Lst_1
Lto_3:
    v_and_b32 v96, 0xffff0000, v64
    v_lshlrev_b32 v104, 16, v64
    v_and_b32 v97, 0xffff0000, v66
    v_lshlrev_b32 v105, 16, v66
    v_and_b32 v98, 0xffff0000, v68
    v_lshlrev_b32 v106, 16, v68
    v_and_b32 v99, 0xffff0000, v70
    v_lshlrev_b32 v107, 16, v70
    v_and_b32 v100, 0xffff0000, v72
    v_lshlrev_b32 v108, 16, v72
    v_and_b32 v101, 0xffff0000, v74
    v_lshlrev_b32 v109, 16, v74
    v_and_b32 v102, 0xffff0000, v76
    v_lshlrev_b32 v110, 16, v76
    v_and_b32 v103, 0xffff0000, v78
    v_lshlrev_b32 v111, 16, v78
    v_rcp_f32 v96, v96
    v_rcp_f32 v97, v97
    v_rcp_f32 v98, v98
    v_rcp_f32 v99, v99
    v_rcp_f32 v100, v100
    v_rcp_f32 v101, v101
    v_rcp_f32 v102, v102
    v_rcp_f32 v103, v103
    v_pk_mul_f32 v[104:105], v[104:105], v[96:97] neg_lo:[1,0] neg_hi:[1,0]
    v_pk_mul_f32 v[106:107], v[106:107], v[98:99] neg_lo:[1,0] neg_hi:[1,0]
    v_pk_mul_f32 v[108:109], v[108:109], v[100:101] neg_lo:[1,0] neg_hi:[1,0]
    v_pk_mul_f32 v[110:111], v[110:111], v[102:103] neg_lo:[1,0] neg_hi:[1,0]
    v_pk_fma_f32 v[176:177], v[176:177], v[96:97], v[104:105]
    v_pk_fma_f32 v[178:179], v[178:179], v[98:99], v[106:107]
    v_pk_fma_f32 v[180:181], v[180:181], v[100:101], v[108:109]
    v_pk_fma_f32 v[182:183], v[182:183], v[102:103], v[110:111]
    v_cvt_pk_bf16_f32 v48, v176, v177
    v_cvt_pk_bf16_f32 v49, v178, v179
    v_cvt_pk_bf16_f32 v50, v180, v181
    v_cvt_pk_bf16_f32 v51, v182, v183
    ds_write_b128 v42, v[48:51] offset:0
    v_pk_fma_f32 v[184:185], v[184:185], v[96:97], v[104:105]
    v_pk_fma_f32 v[186:187], v[186:187], v[98:99], v[106:107]
    v_pk_fma_f32 v[188:189], v[188:189], v[100:101], v[108:109]
    v_pk_fma_f32 v[190:191], v[190:191], v[102:103], v[110:111]
    v_cvt_pk_bf16_f32 v52, v184, v185
    v_cvt_pk_bf16_f32 v53, v186, v187
    v_cvt_pk_bf16_f32 v54, v188, v189
    v_cvt_pk_bf16_f32 v55, v190, v191
    ds_write_b128 v42, v[52:55] offset:4608
    v_pk_fma_f32 v[192:193], v[192:193], v[96:97], v[104:105]
    v_pk_fma_f32 v[194:195], v[194:195], v[98:99], v[106:107]
    v_pk_fma_f32 v[196:197], v[196:197], v[100:101], v[108:109]
    v_pk_fma_f32 v[198:199], v[198:199], v[102:103], v[110:111]
    v_cvt_pk_bf16_f32 v56, v192, v193
    v_cvt_pk_bf16_f32 v57, v194, v195
    v_cvt_pk_bf16_f32 v58, v196, v197
    v_cvt_pk_bf16_f32 v59, v198, v199
    ds_write_b128 v42, v[56:59] offset:9216
    v_pk_fma_f32 v[200:201], v[200:201], v[96:97], v[104:105]
    v_pk_fma_f32 v[202:203], v[202:203], v[98:99], v[106:107]
    v_pk_fma_f32 v[204:205], v[204:205], v[100:101], v[108:109]
    v_pk_fma_f32 v[206:207], v[206:207], v[102:103], v[110:111]
    v_cvt_pk_bf16_f32 v60, v200, v201
    v_cvt_pk_bf16_f32 v61, v202, v203
    v_cvt_pk_bf16_f32 v62, v204, v205
    v_cvt_pk_bf16_f32 v63, v206, v207
    ds_write_b128 v42, v[60:63] offset:13824
    s_waitcnt lgkmcnt(0)
    s_barrier
    ds_read_b128 v[144:147], v40 offset:2512
    ds_read_b128 v[148:151], v40 offset:2768
    ds_read_b128 v[152:155], v40 offset:3024
    ds_read_b128 v[156:159], v40 offset:3280
    ds_read_b128 v[160:163], v40 offset:3536
    ds_read_b128 v[164:167], v40 offset:3792
    ds_read_b128 v[168:171], v40 offset:4048
    ds_read_b128 v[172:175], v40 offset:4304
    s_waitcnt lgkmcnt(0)
    v_mfma_f32_16x16x32_bf16 v[216:219], v[112:115], v[144:147], 0
    ds_read2_b32 v[48:49], v32 offset0:16 offset1:14
    v_mfma_f32_16x16x32_bf16 v[220:223], v[112:115], v[148:151], 0
    ds_read2_b32 v[50:51], v32 offset0:12 offset1:10
    v_mfma_f32_16x16x32_bf16 v[224:227], v[112:115], v[152:155], 0
    ds_read_b128 v[80:83], v40 offset:208
    v_mfma_f32_16x16x32_bf16 v[228:231], v[112:115], v[156:159], 0
    ds_read2_b32 v[52:53], v33 offset0:16 offset1:14
    v_mfma_f32_16x16x32_bf16 v[232:235], v[112:115], v[160:163], 0
    ds_read2_b32 v[54:55], v33 offset0:12 offset1:10
    v_mfma_f32_16x16x32_bf16 v[236:239], v[112:115], v[164:167], 0
    s_bitcmp1_b32 s2, 7
    s_cselect_b32 s50, 1, 0
    s_mul_i32 s51, s50, 28672
    s_add_u32 s51, s51, s74
    s_mul_i32 s50, s50, 442368
    s_add_u32 m0, s51, 0
    s_mov_b32 s63, s50
    ds_read_b128 v[84:87], v40 offset:464
    v_mfma_f32_16x16x32_bf16 v[240:243], v[112:115], v[168:171], 0
    buffer_load_dwordx4 v248, s[52:55], s63 offen lds
    v_mfma_f32_16x16x32_bf16 v[244:247], v[112:115], v[172:175], 0
    ds_read2_b32 v[56:57], v34 offset0:16 offset1:14
    v_mfma_f32_16x16x32_bf16 v[220:223], v[116:119], v[144:147], v[220:223]
    ds_read2_b32 v[58:59], v34 offset0:12 offset1:10
    v_mfma_f32_16x16x32_bf16 v[224:227], v[116:119], v[148:151], v[224:227]
    ds_read_b128 v[88:91], v40 offset:720
    v_mfma_f32_16x16x32_bf16 v[228:231], v[116:119], v[152:155], v[228:231]
    ds_read2_b32 v[60:61], v35 offset0:16 offset1:14
    v_mfma_f32_16x16x32_bf16 v[232:235], v[116:119], v[156:159], v[232:235]
    ds_read2_b32 v[62:63], v35 offset0:12 offset1:10
    v_mfma_f32_16x16x32_bf16 v[236:239], v[116:119], v[160:163], v[236:239]
    ds_read_b128 v[92:95], v40 offset:976
    v_mfma_f32_16x16x32_bf16 v[240:243], v[116:119], v[164:167], v[240:243]
    ds_read2_b32 v[64:65], v36 offset0:16 offset1:14
    v_mfma_f32_16x16x32_bf16 v[244:247], v[116:119], v[168:171], v[244:247]
    ds_read2_b32 v[66:67], v36 offset0:12 offset1:10
    v_mfma_f32_16x16x32_bf16 v[224:227], v[120:123], v[144:147], v[224:227]
    ds_read_b128 v[96:99], v40 offset:1232
    v_mfma_f32_16x16x32_bf16 v[228:231], v[120:123], v[148:151], v[228:231]
    ds_read2_b32 v[68:69], v37 offset0:16 offset1:14
    v_mfma_f32_16x16x32_bf16 v[232:235], v[120:123], v[152:155], v[232:235]
    s_add_u32 m0, s51, 4096
    s_mov_b32 s63, s50
    ds_read2_b32 v[70:71], v37 offset0:12 offset1:10
    v_mfma_f32_16x16x32_bf16 v[236:239], v[120:123], v[156:159], v[236:239]
    buffer_load_dwordx4 v249, s[52:55], s63 offen lds
    v_mfma_f32_16x16x32_bf16 v[240:243], v[120:123], v[160:163], v[240:243]
    ds_read_b128 v[100:103], v40 offset:1488
    v_mfma_f32_16x16x32_bf16 v[244:247], v[120:123], v[164:167], v[244:247]
    ds_read2_b32 v[72:73], v38 offset0:16 offset1:14
    v_mfma_f32_16x16x32_bf16 v[228:231], v[124:127], v[144:147], v[228:231]
    ds_read2_b32 v[74:75], v38 offset0:12 offset1:10
    v_mfma_f32_16x16x32_bf16 v[232:235], v[124:127], v[148:151], v[232:235]
    ds_read_b128 v[104:107], v40 offset:1744
    v_mfma_f32_16x16x32_bf16 v[236:239], v[124:127], v[152:155], v[236:239]
    ds_read2_b32 v[76:77], v39 offset0:16 offset1:14
    v_mfma_f32_16x16x32_bf16 v[240:243], v[124:127], v[156:159], v[240:243]
    ds_read2_b32 v[78:79], v39 offset0:12 offset1:10
    v_mfma_f32_16x16x32_bf16 v[244:247], v[124:127], v[160:163], v[244:247]
    ds_read_b128 v[108:111], v40 offset:2000
    v_mfma_f32_16x16x32_bf16 v[232:235], v[128:131], v[144:147], v[232:235]
    ds_read_b64 v[8:9], v44 offset:0
    v_mfma_f32_16x16x32_bf16 v[236:239], v[128:131], v[148:151], v[236:239]
    ds_read_b64 v[10:11], v44 offset:512
    v_mfma_f32_16x16x32_bf16 v[240:243], v[128:131], v[152:155], v[240:243]
    ds_read_b64 v[12:13], v44 offset:1024
    v_mfma_f32_16x16x32_bf16 v[244:247], v[128:131], v[156:159], v[244:247]
    s_add_u32 m0, s51, 8192
    s_mov_b32 s63, s50
    ds_read_b64 v[14:15], v44 offset:1536
    v_mfma_f32_16x16x32_bf16 v[236:239], v[132:135], v[144:147], v[236:239]
    buffer_load_dwordx4 v250, s[52:55], s63 offen lds
    v_mfma_f32_16x16x32_bf16 v[240:243], v[132:135], v[148:151], v[240:243]
    ds_read_b64 v[16:17], v44 offset:2048
    v_mfma_f32_16x16x32_bf16 v[244:247], v[132:135], v[152:155], v[244:247]
    ds_read_b64 v[18:19], v44 offset:2560
    v_mfma_f32_16x16x32_bf16 v[240:243], v[136:139], v[144:147], v[240:243]
    ds_read_b64 v[20:21], v44 offset:3072
    v_mfma_f32_16x16x32_bf16 v[244:247], v[136:139], v[148:151], v[244:247]
    ds_read_b64 v[22:23], v44 offset:3584
    v_mfma_f32_16x16x32_bf16 v[244:247], v[140:143], v[144:147], v[244:247]
    s_waitcnt lgkmcnt(0)
    v_mfma_f32_16x16x32_bf16 v[216:219], v[48:51], v[80:83], v[216:219]
    ds_read2_b32 v[112:113], v32 offset0:72 offset1:70
    v_mfma_f32_16x16x32_bf16 v[220:223], v[48:51], v[84:87], v[220:223]
    ds_read2_b32 v[114:115], v32 offset0:68 offset1:66
    v_mfma_f32_16x16x32_bf16 v[224:227], v[48:51], v[88:91], v[224:227]
    ds_read_b128 v[144:147], v40 offset:2448
    v_mfma_f32_16x16x32_bf16 v[228:231], v[48:51], v[92:95], v[228:231]
    ds_read2_b32 v[116:117], v33 offset0:72 offset1:70
    v_mfma_f32_16x16x32_bf16 v[232:235], v[48:51], v[96:99], v[232:235]
    ds_read2_b32 v[118:119], v33 offset0:68 offset1:66
    v_mfma_f32_16x16x32_bf16 v[236:239], v[48:51], v[100:103], v[236:239]
    s_add_u32 m0, s51, 12288
    s_mov_b32 s63, s50
    ds_read_b128 v[148:151], v40 offset:2704
    v_mfma_f32_16x16x32_bf16 v[240:243], v[48:51], v[104:107], v[240:243]
    buffer_load_dwordx4 v251, s[52:55], s63 offen lds
    v_mfma_f32_16x16x32_bf16 v[244:247], v[48:51], v[108:111], v[244:247]
    ds_read2_b32 v[120:121], v34 offset0:72 offset1:70
    v_mfma_f32_16x16x32_bf16 v[220:223], v[52:55], v[80:83], v[220:223]
    ds_read2_b32 v[122:123], v34 offset0:68 offset1:66
    v_mfma_f32_16x16x32_bf16 v[224:227], v[52:55], v[84:87], v[224:227]
    ds_read_b128 v[152:155], v40 offset:2960
    v_mfma_f32_16x16x32_bf16 v[228:231], v[52:55], v[88:91], v[228:231]
    ds_read2_b32 v[124:125], v35 offset0:72 offset1:70
    v_mfma_f32_16x16x32_bf16 v[232:235], v[52:55], v[92:95], v[232:235]
    ds_read2_b32 v[126:127], v35 offset0:68 offset1:66
    v_mfma_f32_16x16x32_bf16 v[236:239], v[52:55], v[96:99], v[236:239]
    ds_read_b128 v[156:159], v40 offset:3216
    v_mfma_f32_16x16x32_bf16 v[240:243], v[52:55], v[100:103], v[240:243]
    ds_read2_b32 v[128:129], v36 offset0:72 offset1:70
    v_mfma_f32_16x16x32_bf16 v[244:247], v[52:55], v[104:107], v[244:247]
    ds_read2_b32 v[130:131], v36 offset0:68 offset1:66
    v_mfma_f32_16x16x32_bf16 v[224:227], v[56:59], v[80:83], v[224:227]
    ds_read_b128 v[160:163], v40 offset:3472
    v_mfma_f32_16x16x32_bf16 v[228:231], v[56:59], v[84:87], v[228:231]
    ds_read2_b32 v[132:133], v37 offset0:72 offset1:70
    v_mfma_f32_16x16x32_bf16 v[232:235], v[56:59], v[88:91], v[232:235]
    s_add_u32 m0, s51, 16384
    s_mov_b32 s63, s50
    ds_read2_b32 v[134:135], v37 offset0:68 offset1:66
    v_mfma_f32_16x16x32_bf16 v[236:239], v[56:59], v[92:95], v[236:239]
    buffer_load_dwordx4 v252, s[52:55], s63 offen lds
    v_mfma_f32_16x16x32_bf16 v[240:243], v[56:59], v[96:99], v[240:243]
    ds_read_b128 v[164:167], v40 offset:3728
    v_mfma_f32_16x16x32_bf16 v[244:247], v[56:59], v[100:103], v[244:247]
    ds_read2_b32 v[136:137], v38 offset0:72 offset1:70
    v_mfma_f32_16x16x32_bf16 v[228:231], v[60:63], v[80:83], v[228:231]
    ds_read2_b32 v[138:139], v38 offset0:68 offset1:66
    v_mfma_f32_16x16x32_bf16 v[232:235], v[60:63], v[84:87], v[232:235]
    ds_read_b128 v[168:171], v40 offset:3984
    v_mfma_f32_16x16x32_bf16 v[236:239], v[60:63], v[88:91], v[236:239]
    ds_read2_b32 v[140:141], v39 offset0:72 offset1:70
    v_mfma_f32_16x16x32_bf16 v[240:243], v[60:63], v[92:95], v[240:243]
    ds_read2_b32 v[142:143], v39 offset0:68 offset1:66
    v_mfma_f32_16x16x32_bf16 v[244:247], v[60:63], v[96:99], v[244:247]
    ds_read_b128 v[172:175], v40 offset:4240
    v_mfma_f32_16x16x32_bf16 v[232:235], v[64:67], v[80:83], v[232:235]
    v_lshlrev_b32 v176, 16, v8
    v_and_b32 v177, 0xffff0000, v8
    v_mfma_f32_16x16x32_bf16 v[236:239], v[64:67], v[84:87], v[236:239]
    v_lshlrev_b32 v178, 16, v9
    v_and_b32 v179, 0xffff0000, v9
    v_mfma_f32_16x16x32_bf16 v[240:243], v[64:67], v[88:91], v[240:243]
    v_lshlrev_b32 v180, 16, v10
    v_and_b32 v181, 0xffff0000, v10
    v_mfma_f32_16x16x32_bf16 v[244:247], v[64:67], v[92:95], v[244:247]
    s_add_u32 m0, s51, 20480
    s_mov_b32 s63, s50
    v_lshlrev_b32 v182, 16, v11
    v_and_b32 v183, 0xffff0000, v11
    v_mfma_f32_16x16x32_bf16 v[236:239], v[68:71], v[80:83], v[236:239]
    buffer_load_dwordx4 v253, s[52:55], s63 offen lds
    v_mfma_f32_16x16x32_bf16 v[240:243], v[68:71], v[84:87], v[240:243]
    v_lshlrev_b32 v184, 16, v12
    v_and_b32 v185, 0xffff0000, v12
    v_mfma_f32_16x16x32_bf16 v[244:247], v[68:71], v[88:91], v[244:247]
    v_lshlrev_b32 v186, 16, v13
    v_and_b32 v187, 0xffff0000, v13
    v_mfma_f32_16x16x32_bf16 v[240:243], v[72:75], v[80:83], v[240:243]
    v_lshlrev_b32 v188, 16, v14
    v_and_b32 v189, 0xffff0000, v14
    v_mfma_f32_16x16x32_bf16 v[244:247], v[72:75], v[84:87], v[244:247]
    v_lshlrev_b32 v190, 16, v15
    v_and_b32 v191, 0xffff0000, v15
    v_mfma_f32_16x16x32_bf16 v[244:247], v[76:79], v[80:83], v[244:247]
    s_add_u32 s57, s58, 0
    buffer_store_dwordx4 v[212:215], v255, s[12:15], s57 offen sc1
    s_waitcnt lgkmcnt(0)
    v_mfma_f32_16x16x32_bf16 v[216:219], v[112:115], v[144:147], v[216:219]
    ds_read2_b32 v[48:49], v32 offset0:80 offset1:78
    v_mfma_f32_16x16x32_bf16 v[220:223], v[112:115], v[148:151], v[220:223]
    ds_read2_b32 v[50:51], v32 offset0:76 offset1:74
    v_mfma_f32_16x16x32_bf16 v[224:227], v[112:115], v[152:155], v[224:227]
    ds_read_b128 v[80:83], v40 offset:144
    v_mfma_f32_16x16x32_bf16 v[228:231], v[112:115], v[156:159], v[228:231]
    ds_read2_b32 v[52:53], v33 offset0:80 offset1:78
    v_mfma_f32_16x16x32_bf16 v[232:235], v[112:115], v[160:163], v[232:235]
    ds_read2_b32 v[54:55], v33 offset0:76 offset1:74
    v_mfma_f32_16x16x32_bf16 v[236:239], v[112:115], v[164:167], v[236:239]
    s_add_u32 m0, s51, 24576
    s_mov_b32 s63, s50
    ds_read_b128 v[84:87], v40 offset:400
    v_mfma_f32_16x16x32_bf16 v[240:243], v[112:115], v[168:171], v[240:243]
    buffer_load_dwordx4 v254, s[52:55], s63 offen lds
    v_mfma_f32_16x16x32_bf16 v[244:247], v[112:115], v[172:175], v[244:247]
    ds_read2_b32 v[56:57], v34 offset0:80 offset1:78
    v_mfma_f32_16x16x32_bf16 v[220:223], v[116:119], v[144:147], v[220:223]
    ds_read2_b32 v[58:59], v34 offset0:76 offset1:74
    v_mfma_f32_16x16x32_bf16 v[224:227], v[116:119], v[148:151], v[224:227]
    ds_read_b128 v[88:91], v40 offset:656
    v_mfma_f32_16x16x32_bf16 v[228:231], v[116:119], v[152:155], v[228:231]
    ds_read2_b32 v[60:61], v35 offset0:80 offset1:78
    v_mfma_f32_16x16x32_bf16 v[232:235], v[116:119], v[156:159], v[232:235]
    ds_read2_b32 v[62:63], v35 offset0:76 offset1:74
    v_mfma_f32_16x16x32_bf16 v[236:239], v[116:119], v[160:163], v[236:239]
    ds_read_b128 v[92:95], v40 offset:912
    v_mfma_f32_16x16x32_bf16 v[240:243], v[116:119], v[164:167], v[240:243]
    ds_read2_b32 v[64:65], v36 offset0:80 offset1:78
    v_mfma_f32_16x16x32_bf16 v[244:247], v[116:119], v[168:171], v[244:247]
    ds_read2_b32 v[66:67], v36 offset0:76 offset1:74
    v_mfma_f32_16x16x32_bf16 v[224:227], v[120:123], v[144:147], v[224:227]
    ds_read_b128 v[96:99], v40 offset:1168
    v_mfma_f32_16x16x32_bf16 v[228:231], v[120:123], v[148:151], v[228:231]
    ds_read2_b32 v[68:69], v37 offset0:80 offset1:78
    v_mfma_f32_16x16x32_bf16 v[232:235], v[120:123], v[152:155], v[232:235]
    s_bitcmp1_b32 s2, 7
    s_cselect_b32 s50, 2, 1
    s_mul_i32 s51, s50, 28672
    s_add_u32 s51, s51, s74
    s_mul_i32 s50, s50, 442368
    s_add_u32 m0, s51, 0
    s_mov_b32 s63, s50
    ds_read2_b32 v[70:71], v37 offset0:76 offset1:74
    v_mfma_f32_16x16x32_bf16 v[236:239], v[120:123], v[156:159], v[236:239]
    buffer_load_dwordx4 v248, s[52:55], s63 offen lds
    v_mfma_f32_16x16x32_bf16 v[240:243], v[120:123], v[160:163], v[240:243]
    ds_read_b128 v[100:103], v40 offset:1424
    v_mfma_f32_16x16x32_bf16 v[244:247], v[120:123], v[164:167], v[244:247]
    ds_read2_b32 v[72:73], v38 offset0:80 offset1:78
    v_mfma_f32_16x16x32_bf16 v[228:231], v[124:127], v[144:147], v[228:231]
    ds_read2_b32 v[74:75], v38 offset0:76 offset1:74
    v_mfma_f32_16x16x32_bf16 v[232:235], v[124:127], v[148:151], v[232:235]
    ds_read_b128 v[104:107], v40 offset:1680
    v_mfma_f32_16x16x32_bf16 v[236:239], v[124:127], v[152:155], v[236:239]
    ds_read2_b32 v[76:77], v39 offset0:80 offset1:78
    v_mfma_f32_16x16x32_bf16 v[240:243], v[124:127], v[156:159], v[240:243]
    ds_read2_b32 v[78:79], v39 offset0:76 offset1:74
    v_mfma_f32_16x16x32_bf16 v[244:247], v[124:127], v[160:163], v[244:247]
    ds_read_b128 v[108:111], v40 offset:1936
    v_mfma_f32_16x16x32_bf16 v[232:235], v[128:131], v[144:147], v[232:235]
    v_lshlrev_b32 v192, 16, v16
    v_and_b32 v193, 0xffff0000, v16
    v_mfma_f32_16x16x32_bf16 v[236:239], v[128:131], v[148:151], v[236:239]
    v_lshlrev_b32 v194, 16, v17
    v_and_b32 v195, 0xffff0000, v17
    v_mfma_f32_16x16x32_bf16 v[240:243], v[128:131], v[152:155], v[240:243]
    v_lshlrev_b32 v196, 16, v18
    v_and_b32 v197, 0xffff0000, v18
    v_mfma_f32_16x16x32_bf16 v[244:247], v[128:131], v[156:159], v[244:247]
    s_add_u32 m0, s51, 4096
    s_mov_b32 s63, s50
    v_lshlrev_b32 v198, 16, v19
    v_and_b32 v199, 0xffff0000, v19
    v_mfma_f32_16x16x32_bf16 v[236:239], v[132:135], v[144:147], v[236:239]
    buffer_load_dwordx4 v249, s[52:55], s63 offen lds
    v_mfma_f32_16x16x32_bf16 v[240:243], v[132:135], v[148:151], v[240:243]
    v_lshlrev_b32 v200, 16, v20
    v_and_b32 v201, 0xffff0000, v20
    v_mfma_f32_16x16x32_bf16 v[244:247], v[132:135], v[152:155], v[244:247]
    v_lshlrev_b32 v202, 16, v21
    v_and_b32 v203, 0xffff0000, v21
    v_mfma_f32_16x16x32_bf16 v[240:243], v[136:139], v[144:147], v[240:243]
    v_lshlrev_b32 v204, 16, v22
    v_and_b32 v205, 0xffff0000, v22
    v_mfma_f32_16x16x32_bf16 v[244:247], v[136:139], v[148:151], v[244:247]
    v_lshlrev_b32 v206, 16, v23
    v_and_b32 v207, 0xffff0000, v23
    v_mfma_f32_16x16x32_bf16 v[244:247], v[140:143], v[144:147], v[244:247]
    s_add_u32 s57, s58, 163840
    buffer_store_dwordx4 v[212:215], v255, s[12:15], s57 offen sc1
    s_waitcnt lgkmcnt(0)
    v_mfma_f32_16x16x32_bf16 v[216:219], v[48:51], v[80:83], v[216:219]
    ds_read2_b32 v[112:113], v32 offset0:136 offset1:134
    v_mfma_f32_16x16x32_bf16 v[220:223], v[48:51], v[84:87], v[220:223]
    ds_read2_b32 v[114:115], v32 offset0:132 offset1:130
    v_mfma_f32_16x16x32_bf16 v[224:227], v[48:51], v[88:91], v[224:227]
    ds_read_b128 v[144:147], v40 offset:2384
    v_mfma_f32_16x16x32_bf16 v[228:231], v[48:51], v[92:95], v[228:231]
    ds_read2_b32 v[116:117], v33 offset0:136 offset1:134
    v_mfma_f32_16x16x32_bf16 v[232:235], v[48:51], v[96:99], v[232:235]
    ds_read2_b32 v[118:119], v33 offset0:132 offset1:130
    v_mfma_f32_16x16x32_bf16 v[236:239], v[48:51], v[100:103], v[236:239]
    s_add_u32 m0, s51, 8192
    s_mov_b32 s63, s50
    ds_read_b128 v[148:151], v40 offset:2640
    v_mfma_f32_16x16x32_bf16 v[240:243], v[48:51], v[104:107], v[240:243]
    buffer_load_dwordx4 v250, s[52:55], s63 offen lds
    v_mfma_f32_16x16x32_bf16 v[244:247], v[48:51], v[108:111], v[244:247]
    ds_read2_b32 v[120:121], v34 offset0:136 offset1:134
    v_mfma_f32_16x16x32_bf16 v[220:223], v[52:55], v[80:83], v[220:223]
    ds_read2_b32 v[122:123], v34 offset0:132 offset1:130
    v_mfma_f32_16x16x32_bf16 v[224:227], v[52:55], v[84:87], v[224:227]
    ds_read_b128 v[152:155], v40 offset:2896
    v_mfma_f32_16x16x32_bf16 v[228:231], v[52:55], v[88:91], v[228:231]
    ds_read2_b32 v[124:125], v35 offset0:136 offset1:134
    v_mfma_f32_16x16x32_bf16 v[232:235], v[52:55], v[92:95], v[232:235]
    ds_read2_b32 v[126:127], v35 offset0:132 offset1:130
    v_mfma_f32_16x16x32_bf16 v[236:239], v[52:55], v[96:99], v[236:239]
    ds_read_b128 v[156:159], v40 offset:3152
    v_mfma_f32_16x16x32_bf16 v[240:243], v[52:55], v[100:103], v[240:243]
    ds_read2_b32 v[128:129], v36 offset0:136 offset1:134
    v_mfma_f32_16x16x32_bf16 v[244:247], v[52:55], v[104:107], v[244:247]
    ds_read2_b32 v[130:131], v36 offset0:132 offset1:130
    v_mfma_f32_16x16x32_bf16 v[224:227], v[56:59], v[80:83], v[224:227]
    ds_read_b128 v[160:163], v40 offset:3408
    v_mfma_f32_16x16x32_bf16 v[228:231], v[56:59], v[84:87], v[228:231]
    ds_read2_b32 v[132:133], v37 offset0:136 offset1:134
    v_mfma_f32_16x16x32_bf16 v[232:235], v[56:59], v[88:91], v[232:235]
    s_add_u32 m0, s51, 12288
    s_mov_b32 s63, s50
    ds_read2_b32 v[134:135], v37 offset0:132 offset1:130
    v_mfma_f32_16x16x32_bf16 v[236:239], v[56:59], v[92:95], v[236:239]
    buffer_load_dwordx4 v251, s[52:55], s63 offen lds
    v_mfma_f32_16x16x32_bf16 v[240:243], v[56:59], v[96:99], v[240:243]
    ds_read_b128 v[164:167], v40 offset:3664
    v_mfma_f32_16x16x32_bf16 v[244:247], v[56:59], v[100:103], v[244:247]
    ds_read2_b32 v[136:137], v38 offset0:136 offset1:134
    v_mfma_f32_16x16x32_bf16 v[228:231], v[60:63], v[80:83], v[228:231]
    ds_read2_b32 v[138:139], v38 offset0:132 offset1:130
    v_mfma_f32_16x16x32_bf16 v[232:235], v[60:63], v[84:87], v[232:235]
    ds_read_b128 v[168:171], v40 offset:3920
    v_mfma_f32_16x16x32_bf16 v[236:239], v[60:63], v[88:91], v[236:239]
    ds_read2_b32 v[140:141], v39 offset0:136 offset1:134
    v_mfma_f32_16x16x32_bf16 v[240:243], v[60:63], v[92:95], v[240:243]
    ds_read2_b32 v[142:143], v39 offset0:132 offset1:130
    v_mfma_f32_16x16x32_bf16 v[244:247], v[60:63], v[96:99], v[244:247]
    ds_read_b128 v[172:175], v40 offset:4176
    v_mfma_f32_16x16x32_bf16 v[232:235], v[64:67], v[80:83], v[232:235]
    v_mfma_f32_16x16x32_bf16 v[236:239], v[64:67], v[84:87], v[236:239]
    v_mfma_f32_16x16x32_bf16 v[240:243], v[64:67], v[88:91], v[240:243]
    v_mfma_f32_16x16x32_bf16 v[244:247], v[64:67], v[92:95], v[244:247]
    s_add_u32 m0, s51, 16384
    s_mov_b32 s63, s50
    v_mfma_f32_16x16x32_bf16 v[236:239], v[68:71], v[80:83], v[236:239]
    buffer_load_dwordx4 v252, s[52:55], s63 offen lds
    v_mfma_f32_16x16x32_bf16 v[240:243], v[68:71], v[84:87], v[240:243]
    v_add_f32 v216, v216, v176
    v_add_f32 v217, v217, v177
    v_mfma_f32_16x16x32_bf16 v[244:247], v[68:71], v[88:91], v[244:247]
    v_add_f32 v218, v218, v178
    v_add_f32 v219, v219, v179
    v_mfma_f32_16x16x32_bf16 v[240:243], v[72:75], v[80:83], v[240:243]
    v_add_f32 v220, v220, v180
    v_add_f32 v221, v221, v181
    v_mfma_f32_16x16x32_bf16 v[244:247], v[72:75], v[84:87], v[244:247]
    v_add_f32 v222, v222, v182
    v_add_f32 v223, v223, v183
    v_mfma_f32_16x16x32_bf16 v[244:247], v[76:79], v[80:83], v[244:247]
    s_add_u32 s57, s58, 327680
    buffer_store_dwordx4 v[212:215], v255, s[12:15], s57 offen sc1
    s_waitcnt lgkmcnt(0)
    v_mfma_f32_16x16x32_bf16 v[216:219], v[112:115], v[144:147], v[216:219]
    ds_read2_b32 v[48:49], v32 offset0:144 offset1:142
    v_mfma_f32_16x16x32_bf16 v[220:223], v[112:115], v[148:151], v[220:223]
    ds_read2_b32 v[50:51], v32 offset0:140 offset1:138
    v_mfma_f32_16x16x32_bf16 v[224:227], v[112:115], v[152:155], v[224:227]
    ds_read_b128 v[80:83], v40 offset:80
    v_mfma_f32_16x16x32_bf16 v[228:231], v[112:115], v[156:159], v[228:231]
    ds_read2_b32 v[52:53], v33 offset0:144 offset1:142
    v_mfma_f32_16x16x32_bf16 v[232:235], v[112:115], v[160:163], v[232:235]
    ds_read2_b32 v[54:55], v33 offset0:140 offset1:138
    v_mfma_f32_16x16x32_bf16 v[236:239], v[112:115], v[164:167], v[236:239]
    s_add_u32 m0, s51, 20480
    s_mov_b32 s63, s50
    ds_read_b128 v[84:87], v40 offset:336
    v_mfma_f32_16x16x32_bf16 v[240:243], v[112:115], v[168:171], v[240:243]
    buffer_load_dwordx4 v253, s[52:55], s63 offen lds
    v_mfma_f32_16x16x32_bf16 v[244:247], v[112:115], v[172:175], v[244:247]
    ds_read2_b32 v[56:57], v34 offset0:144 offset1:142
    v_mfma_f32_16x16x32_bf16 v[220:223], v[116:119], v[144:147], v[220:223]
    ds_read2_b32 v[58:59], v34 offset0:140 offset1:138
    v_mfma_f32_16x16x32_bf16 v[224:227], v[116:119], v[148:151], v[224:227]
    ds_read_b128 v[88:91], v40 offset:592
    v_mfma_f32_16x16x32_bf16 v[228:231], v[116:119], v[152:155], v[228:231]
    ds_read2_b32 v[60:61], v35 offset0:144 offset1:142
    v_mfma_f32_16x16x32_bf16 v[232:235], v[116:119], v[156:159], v[232:235]
    ds_read2_b32 v[62:63], v35 offset0:140 offset1:138
    v_mfma_f32_16x16x32_bf16 v[236:239], v[116:119], v[160:163], v[236:239]
    ds_read_b128 v[92:95], v40 offset:848
    v_mfma_f32_16x16x32_bf16 v[240:243], v[116:119], v[164:167], v[240:243]
    ds_read2_b32 v[64:65], v36 offset0:144 offset1:142
    v_mfma_f32_16x16x32_bf16 v[244:247], v[116:119], v[168:171], v[244:247]
    ds_read2_b32 v[66:67], v36 offset0:140 offset1:138
    v_mfma_f32_16x16x32_bf16 v[224:227], v[120:123], v[144:147], v[224:227]
    ds_read_b128 v[96:99], v40 offset:1104
    v_mfma_f32_16x16x32_bf16 v[228:231], v[120:123], v[148:151], v[228:231]
    ds_read2_b32 v[68:69], v37 offset0:144 offset1:142
    v_mfma_f32_16x16x32_bf16 v[232:235], v[120:123], v[152:155], v[232:235]
    s_add_u32 m0, s51, 24576
    s_mov_b32 s63, s50
    ds_read2_b32 v[70:71], v37 offset0:140 offset1:138
    v_mfma_f32_16x16x32_bf16 v[236:239], v[120:123], v[156:159], v[236:239]
    buffer_load_dwordx4 v254, s[52:55], s63 offen lds
    v_mfma_f32_16x16x32_bf16 v[240:243], v[120:123], v[160:163], v[240:243]
    ds_read_b128 v[100:103], v40 offset:1360
    v_mfma_f32_16x16x32_bf16 v[244:247], v[120:123], v[164:167], v[244:247]
    ds_read2_b32 v[72:73], v38 offset0:144 offset1:142
    v_mfma_f32_16x16x32_bf16 v[228:231], v[124:127], v[144:147], v[228:231]
    ds_read2_b32 v[74:75], v38 offset0:140 offset1:138
    v_mfma_f32_16x16x32_bf16 v[232:235], v[124:127], v[148:151], v[232:235]
    ds_read_b128 v[104:107], v40 offset:1616
    v_mfma_f32_16x16x32_bf16 v[236:239], v[124:127], v[152:155], v[236:239]
    ds_read2_b32 v[76:77], v39 offset0:144 offset1:142
    v_mfma_f32_16x16x32_bf16 v[240:243], v[124:127], v[156:159], v[240:243]
    ds_read2_b32 v[78:79], v39 offset0:140 offset1:138
    v_mfma_f32_16x16x32_bf16 v[244:247], v[124:127], v[160:163], v[244:247]
    ds_read_b128 v[108:111], v40 offset:1872
    v_mfma_f32_16x16x32_bf16 v[232:235], v[128:131], v[144:147], v[232:235]
    v_mfma_f32_16x16x32_bf16 v[236:239], v[128:131], v[148:151], v[236:239]
    v_add_f32 v224, v224, v184
    v_add_f32 v225, v225, v185
    v_mfma_f32_16x16x32_bf16 v[240:243], v[128:131], v[152:155], v[240:243]
    v_add_f32 v226, v226, v186
    v_add_f32 v227, v227, v187
    v_mfma_f32_16x16x32_bf16 v[244:247], v[128:131], v[156:159], v[244:247]
    s_bitcmp1_b32 s2, 7
    s_cselect_b32 s50, 0, 2
    s_mul_i32 s51, s50, 28672
    s_add_u32 s51, s51, s74
    s_mul_i32 s50, s50, 442368
    s_add_u32 m0, s51, 0
    s_mov_b32 s63, s50
    v_add_f32 v228, v228, v188
    v_add_f32 v229, v229, v189
    v_mfma_f32_16x16x32_bf16 v[236:239], v[132:135], v[144:147], v[236:239]
    buffer_load_dwordx4 v248, s[52:55], s63 offen lds
    v_mfma_f32_16x16x32_bf16 v[240:243], v[132:135], v[148:151], v[240:243]
    v_add_f32 v230, v230, v190
    v_add_f32 v231, v231, v191
    v_mfma_f32_16x16x32_bf16 v[244:247], v[132:135], v[152:155], v[244:247]
    v_mfma_f32_16x16x32_bf16 v[240:243], v[136:139], v[144:147], v[240:243]
    v_mfma_f32_16x16x32_bf16 v[244:247], v[136:139], v[148:151], v[244:247]
    v_mfma_f32_16x16x32_bf16 v[244:247], v[140:143], v[144:147], v[244:247]
    s_add_u32 s57, s58, 491520
    buffer_store_dwordx4 v[212:215], v255, s[12:15], s57 offen sc1
    s_waitcnt lgkmcnt(0)
    v_mfma_f32_16x16x32_bf16 v[244:247], v[48:51], v[108:111], v[244:247]
    ds_read2_b32 v[112:113], v32 offset0:200 offset1:198
    v_mfma_f32_16x16x32_bf16 v[244:247], v[52:55], v[104:107], v[244:247]
    ds_read2_b32 v[114:115], v32 offset0:196 offset1:194
    v_mfma_f32_16x16x32_bf16 v[244:247], v[56:59], v[100:103], v[244:247]
    ds_read_b128 v[144:147], v40 offset:2320
    v_mfma_f32_16x16x32_bf16 v[244:247], v[60:63], v[96:99], v[244:247]
    ds_read2_b32 v[116:117], v33 offset0:200 offset1:198
    v_mfma_f32_16x16x32_bf16 v[244:247], v[64:67], v[92:95], v[244:247]
    ds_read2_b32 v[118:119], v33 offset0:196 offset1:194
    v_mfma_f32_16x16x32_bf16 v[244:247], v[68:71], v[88:91], v[244:247]
    s_add_u32 m0, s51, 4096
    s_mov_b32 s63, s50
    ds_read_b128 v[148:151], v40 offset:2576
    v_mfma_f32_16x16x32_bf16 v[244:247], v[72:75], v[84:87], v[244:247]
    buffer_load_dwordx4 v249, s[52:55], s63 offen lds
    v_mfma_f32_16x16x32_bf16 v[244:247], v[76:79], v[80:83], v[244:247]
    ds_read2_b32 v[120:121], v34 offset0:200 offset1:198
    v_mfma_f32_16x16x32_bf16 v[240:243], v[48:51], v[104:107], v[240:243]
    ds_read2_b32 v[122:123], v34 offset0:196 offset1:194
    v_mfma_f32_16x16x32_bf16 v[240:243], v[52:55], v[100:103], v[240:243]
    ds_read_b128 v[152:155], v40 offset:2832
    v_mfma_f32_16x16x32_bf16 v[240:243], v[56:59], v[96:99], v[240:243]
    ds_read2_b32 v[124:125], v35 offset0:200 offset1:198
    v_mfma_f32_16x16x32_bf16 v[240:243], v[60:63], v[92:95], v[240:243]
    ds_read2_b32 v[126:127], v35 offset0:196 offset1:194
    v_mfma_f32_16x16x32_bf16 v[240:243], v[64:67], v[88:91], v[240:243]
    ds_read_b128 v[156:159], v40 offset:3088
    v_mfma_f32_16x16x32_bf16 v[240:243], v[68:71], v[84:87], v[240:243]
    ds_read2_b32 v[128:129], v36 offset0:200 offset1:198
    v_mfma_f32_16x16x32_bf16 v[240:243], v[72:75], v[80:83], v[240:243]
    ds_read2_b32 v[130:131], v36 offset0:196 offset1:194
    v_mfma_f32_16x16x32_bf16 v[236:239], v[48:51], v[100:103], v[236:239]
    ds_read_b128 v[160:163], v40 offset:3344
    v_mfma_f32_16x16x32_bf16 v[236:239], v[52:55], v[96:99], v[236:239]
    ds_read2_b32 v[132:133], v37 offset0:200 offset1:198
    v_mfma_f32_16x16x32_bf16 v[236:239], v[56:59], v[92:95], v[236:239]
    s_add_u32 m0, s51, 8192
    s_mov_b32 s63, s50
    ds_read2_b32 v[134:135], v37 offset0:196 offset1:194
    v_mfma_f32_16x16x32_bf16 v[236:239], v[60:63], v[88:91], v[236:239]
    buffer_load_dwordx4 v250, s[52:55], s63 offen lds
    v_mfma_f32_16x16x32_bf16 v[236:239], v[64:67], v[84:87], v[236:239]
    ds_read_b128 v[164:167], v40 offset:3600
    v_mfma_f32_16x16x32_bf16 v[236:239], v[68:71], v[80:83], v[236:239]
    ds_read2_b32 v[136:137], v38 offset0:200 offset1:198
    v_mfma_f32_16x16x32_bf16 v[232:235], v[48:51], v[96:99], v[232:235]
    ds_read2_b32 v[138:139], v38 offset0:196 offset1:194
    v_mfma_f32_16x16x32_bf16 v[232:235], v[52:55], v[92:95], v[232:235]
    ds_read_b128 v[168:171], v40 offset:3856
    v_mfma_f32_16x16x32_bf16 v[232:235], v[56:59], v[88:91], v[232:235]
    ds_read2_b32 v[140:141], v39 offset0:200 offset1:198
    v_mfma_f32_16x16x32_bf16 v[232:235], v[60:63], v[84:87], v[232:235]
    ds_read2_b32 v[142:143], v39 offset0:196 offset1:194
    v_mfma_f32_16x16x32_bf16 v[232:235], v[64:67], v[80:83], v[232:235]
    ds_read_b128 v[172:175], v40 offset:4112
    v_mfma_f32_16x16x32_bf16 v[228:231], v[48:51], v[92:95], v[228:231]
    v_add_f32 v244, v244, v204
    v_add_f32 v245, v245, v205
    v_mfma_f32_16x16x32_bf16 v[228:231], v[52:55], v[88:91], v[228:231]
    v_add_f32 v246, v246, v206
    v_add_f32 v247, v247, v207
    v_mfma_f32_16x16x32_bf16 v[228:231], v[56:59], v[84:87], v[228:231]
    v_add_f32 v240, v240, v200
    v_add_f32 v241, v241, v201
    v_mfma_f32_16x16x32_bf16 v[228:231], v[60:63], v[80:83], v[228:231]
    s_add_u32 m0, s51, 12288
    s_mov_b32 s63, s50
    v_add_f32 v242, v242, v202
    v_add_f32 v243, v243, v203
    v_mfma_f32_16x16x32_bf16 v[224:227], v[48:51], v[88:91], v[224:227]
    buffer_load_dwordx4 v251, s[52:55], s63 offen lds
    v_mfma_f32_16x16x32_bf16 v[224:227], v[52:55], v[84:87], v[224:227]
    v_mfma_f32_16x16x32_bf16 v[224:227], v[56:59], v[80:83], v[224:227]
    v_mfma_f32_16x16x32_bf16 v[220:223], v[48:51], v[84:87], v[220:223]
    v_mfma_f32_16x16x32_bf16 v[220:223], v[52:55], v[80:83], v[220:223]
    v_mfma_f32_16x16x32_bf16 v[216:219], v[48:51], v[80:83], v[216:219]
    s_waitcnt lgkmcnt(0)
    v_mfma_f32_16x16x32_bf16 v[244:247], v[112:115], v[172:175], v[244:247]
    ds_read2_b32 v[48:49], v32 offset0:208 offset1:206
    v_mfma_f32_16x16x32_bf16 v[244:247], v[116:119], v[168:171], v[244:247]
    ds_read2_b32 v[50:51], v32 offset0:204 offset1:202
    v_mfma_f32_16x16x32_bf16 v[244:247], v[120:123], v[164:167], v[244:247]
    ds_read_b128 v[80:83], v40 offset:16
    v_mfma_f32_16x16x32_bf16 v[244:247], v[124:127], v[160:163], v[244:247]
    ds_read2_b32 v[52:53], v33 offset0:208 offset1:206
    v_mfma_f32_16x16x32_bf16 v[244:247], v[128:131], v[156:159], v[244:247]
    ds_read2_b32 v[54:55], v33 offset0:204 offset1:202
    v_mfma_f32_16x16x32_bf16 v[244:247], v[132:135], v[152:155], v[244:247]
    s_add_u32 m0, s51, 16384
    s_mov_b32 s63, s50
    ds_read_b128 v[84:87], v40 offset:272
    v_mfma_f32_16x16x32_bf16 v[244:247], v[136:139], v[148:151], v[244:247]
    buffer_load_dwordx4 v252, s[52:55], s63 offen lds
    v_mfma_f32_16x16x32_bf16 v[244:247], v[140:143], v[144:147], v[244:247]
    ds_read2_b32 v[56:57], v34 offset0:208 offset1:206
    v_mfma_f32_16x16x32_bf16 v[240:243], v[112:115], v[168:171], v[240:243]
    ds_read2_b32 v[58:59], v34 offset0:204 offset1:202
    v_mfma_f32_16x16x32_bf16 v[240:243], v[116:119], v[164:167], v[240:243]
    ds_read_b128 v[88:91], v40 offset:528
    v_mfma_f32_16x16x32_bf16 v[240:243], v[120:123], v[160:163], v[240:243]
    ds_read2_b32 v[60:61], v35 offset0:208 offset1:206
    v_mfma_f32_16x16x32_bf16 v[240:243], v[124:127], v[156:159], v[240:243]
    ds_read2_b32 v[62:63], v35 offset0:204 offset1:202
    v_mfma_f32_16x16x32_bf16 v[240:243], v[128:131], v[152:155], v[240:243]
    ds_read_b128 v[92:95], v40 offset:784
    v_mfma_f32_16x16x32_bf16 v[240:243], v[132:135], v[148:151], v[240:243]
    ds_read2_b32 v[64:65], v36 offset0:208 offset1:206
    v_mfma_f32_16x16x32_bf16 v[240:243], v[136:139], v[144:147], v[240:243]
    ds_read2_b32 v[66:67], v36 offset0:204 offset1:202
    v_mfma_f32_16x16x32_bf16 v[236:239], v[112:115], v[164:167], v[236:239]
    ds_read_b128 v[96:99], v40 offset:1040
    v_mfma_f32_16x16x32_bf16 v[236:239], v[116:119], v[160:163], v[236:239]
    ds_read2_b32 v[68:69], v37 offset0:208 offset1:206
    v_mfma_f32_16x16x32_bf16 v[236:239], v[120:123], v[156:159], v[236:239]
    s_add_u32 m0, s51, 20480
    s_mov_b32 s63, s50
    ds_read2_b32 v[70:71], v37 offset0:204 offset1:202
    v_mfma_f32_16x16x32_bf16 v[236:239], v[124:127], v[152:155], v[236:239]
    buffer_load_dwordx4 v253, s[52:55], s63 offen lds
    v_mfma_f32_16x16x32_bf16 v[236:239], v[128:131], v[148:151], v[236:239]
    ds_read_b128 v[100:103], v40 offset:1296
    v_mfma_f32_16x16x32_bf16 v[236:239], v[132:135], v[144:147], v[236:239]
    ds_read2_b32 v[72:73], v38 offset0:208 offset1:206
    v_mfma_f32_16x16x32_bf16 v[232:235], v[112:115], v[160:163], v[232:235]
    ds_read2_b32 v[74:75], v38 offset0:204 offset1:202
    v_mfma_f32_16x16x32_bf16 v[232:235], v[116:119], v[156:159], v[232:235]
    ds_read_b128 v[104:107], v40 offset:1552
    v_mfma_f32_16x16x32_bf16 v[232:235], v[120:123], v[152:155], v[232:235]
    ds_read2_b32 v[76:77], v39 offset0:208 offset1:206
    v_mfma_f32_16x16x32_bf16 v[232:235], v[124:127], v[148:151], v[232:235]
    ds_read2_b32 v[78:79], v39 offset0:204 offset1:202
    v_mfma_f32_16x16x32_bf16 v[232:235], v[128:131], v[144:147], v[232:235]
    ds_read_b128 v[108:111], v40 offset:1808
    v_mfma_f32_16x16x32_bf16 v[228:231], v[112:115], v[156:159], v[228:231]
    v_mfma_f32_16x16x32_bf16 v[228:231], v[116:119], v[152:155], v[228:231]
    v_add_f32 v236, v236, v196
    v_add_f32 v237, v237, v197
    v_mfma_f32_16x16x32_bf16 v[228:231], v[120:123], v[148:151], v[228:231]
    v_add_f32 v238, v238, v198
    v_add_f32 v239, v239, v199
    v_mfma_f32_16x16x32_bf16 v[228:231], v[124:127], v[144:147], v[228:231]
    s_add_u32 m0, s51, 24576
    s_mov_b32 s63, s50
    v_add_f32 v232, v232, v192
    v_add_f32 v233, v233, v193
    v_mfma_f32_16x16x32_bf16 v[224:227], v[112:115], v[152:155], v[224:227]
    buffer_load_dwordx4 v254, s[52:55], s63 offen lds
    v_mfma_f32_16x16x32_bf16 v[224:227], v[116:119], v[148:151], v[224:227]
    v_add_f32 v234, v234, v194
    v_add_f32 v235, v235, v195
    v_mfma_f32_16x16x32_bf16 v[224:227], v[120:123], v[144:147], v[224:227]
    v_mfma_f32_16x16x32_bf16 v[220:223], v[112:115], v[148:151], v[220:223]
    v_mfma_f32_16x16x32_bf16 v[220:223], v[116:119], v[144:147], v[220:223]
    v_mfma_f32_16x16x32_bf16 v[216:219], v[112:115], v[144:147], v[216:219]
    s_waitcnt lgkmcnt(0)
    v_mfma_f32_16x16x32_bf16 v[244:247], v[48:51], v[108:111], v[244:247]
    v_mfma_f32_16x16x32_bf16 v[244:247], v[52:55], v[104:107], v[244:247]
    buffer_load_dwordx2 v[208:209], v45, s[64:67], s62 offen sc1
    v_mfma_f32_16x16x32_bf16 v[244:247], v[56:59], v[100:103], v[244:247]
    v_mfma_f32_16x16x32_bf16 v[244:247], v[60:63], v[96:99], v[244:247]
    buffer_load_dwordx2 v[210:211], v46, s[64:67], s62 offen sc1
    v_mfma_f32_16x16x32_bf16 v[244:247], v[64:67], v[92:95], v[244:247]
    v_mfma_f32_16x16x32_bf16 v[244:247], v[68:71], v[88:91], v[244:247]
    v_mfma_f32_16x16x32_bf16 v[244:247], v[72:75], v[84:87], v[244:247]
    v_mfma_f32_16x16x32_bf16 v[244:247], v[76:79], v[80:83], v[244:247]
    v_mfma_f32_16x16x32_bf16 v[240:243], v[48:51], v[104:107], v[240:243]
    v_mfma_f32_16x16x32_bf16 v[240:243], v[52:55], v[100:103], v[240:243]
    v_mfma_f32_16x16x32_bf16 v[240:243], v[56:59], v[96:99], v[240:243]
    v_mfma_f32_16x16x32_bf16 v[240:243], v[60:63], v[92:95], v[240:243]
    v_mfma_f32_16x16x32_bf16 v[240:243], v[64:67], v[88:91], v[240:243]
    s_nop 2
    v_cvt_pk_bf16_f32 v158, v244, v245
    v_mfma_f32_16x16x32_bf16 v[240:243], v[68:71], v[84:87], v[240:243]
    v_cvt_pk_bf16_f32 v159, v246, v247
    v_mfma_f32_16x16x32_bf16 v[240:243], v[72:75], v[80:83], v[240:243]
    ds_write_b64 v44, v[158:159] offset:3584
    v_mfma_f32_16x16x32_bf16 v[236:239], v[48:51], v[100:103], v[236:239]
    v_mfma_f32_16x16x32_bf16 v[236:239], v[52:55], v[96:99], v[236:239]
    v_mfma_f32_16x16x32_bf16 v[236:239], v[56:59], v[92:95], v[236:239]
    v_mfma_f32_16x16x32_bf16 v[236:239], v[60:63], v[88:91], v[236:239]
    v_mfma_f32_16x16x32_bf16 v[236:239], v[64:67], v[84:87], v[236:239]
    s_nop 1
    v_cvt_pk_bf16_f32 v156, v240, v241
    v_mfma_f32_16x16x32_bf16 v[236:239], v[68:71], v[80:83], v[236:239]
    v_cvt_pk_bf16_f32 v157, v242, v243
    v_mfma_f32_16x16x32_bf16 v[232:235], v[48:51], v[96:99], v[232:235]
    ds_write_b64 v44, v[156:157] offset:3072
    v_mfma_f32_16x16x32_bf16 v[232:235], v[52:55], v[92:95], v[232:235]
    v_mfma_f32_16x16x32_bf16 v[232:235], v[56:59], v[88:91], v[232:235]
    v_mfma_f32_16x16x32_bf16 v[232:235], v[60:63], v[84:87], v[232:235]
    v_mfma_f32_16x16x32_bf16 v[232:235], v[64:67], v[80:83], v[232:235]
    s_nop 0
    v_cvt_pk_bf16_f32 v154, v236, v237
    v_mfma_f32_16x16x32_bf16 v[228:231], v[48:51], v[92:95], v[228:231]
    v_cvt_pk_bf16_f32 v155, v238, v239
    v_mfma_f32_16x16x32_bf16 v[228:231], v[52:55], v[88:91], v[228:231]
    ds_write_b64 v44, v[154:155] offset:2560
    v_mfma_f32_16x16x32_bf16 v[228:231], v[56:59], v[84:87], v[228:231]
    v_mfma_f32_16x16x32_bf16 v[228:231], v[60:63], v[80:83], v[228:231]
    v_cvt_pk_bf16_f32 v152, v232, v233
    v_mfma_f32_16x16x32_bf16 v[224:227], v[48:51], v[88:91], v[224:227]
    v_cvt_pk_bf16_f32 v153, v234, v235
    v_mfma_f32_16x16x32_bf16 v[224:227], v[52:55], v[84:87], v[224:227]
    ds_write_b64 v44, v[152:153] offset:2048
    v_mfma_f32_16x16x32_bf16 v[224:227], v[56:59], v[80:83], v[224:227]
    s_nop 1
    v_cvt_pk_bf16_f32 v150, v228, v229
    v_mfma_f32_16x16x32_bf16 v[220:223], v[48:51], v[84:87], v[220:223]
    v_cvt_pk_bf16_f32 v151, v230, v231
    v_mfma_f32_16x16x32_bf16 v[220:223], v[52:55], v[80:83], v[220:223]
    ds_write_b64 v44, v[150:151] offset:1536
    v_mfma_f32_16x16x32_bf16 v[216:219], v[48:51], v[80:83], v[216:219]
    v_cvt_pk_bf16_f32 v148, v224, v225
    v_cvt_pk_bf16_f32 v149, v226, v227
    ds_write_b64 v44, v[148:149] offset:1024
    s_nop 2
    s_nop 0
    v_cvt_pk_bf16_f32 v146, v220, v221
    v_cvt_pk_bf16_f32 v147, v222, v223
    ds_write_b64 v44, v[146:147] offset:512
    v_cvt_pk_bf16_f32 v144, v216, v217
    v_cvt_pk_bf16_f32 v145, v218, v219
    ds_write_b64 v44, v[144:145] offset:0
    s_waitcnt vmcnt(8)
    s_waitcnt lgkmcnt(0)
    s_barrier
    s_nop 0
    ds_read_b64_tr_b16 v[64:65], v47 offset:0
    ds_read_b64_tr_b16 v[66:67], v47 offset:32
    ds_read_b64_tr_b16 v[68:69], v47 offset:256
    ds_read_b64_tr_b16 v[70:71], v47 offset:288
    ds_read_b64_tr_b16 v[72:73], v47 offset:512
    ds_read_b64_tr_b16 v[74:75], v47 offset:544
    ds_read_b64_tr_b16 v[76:77], v47 offset:768
    ds_read_b64_tr_b16 v[78:79], v47 offset:800
    s_waitcnt lgkmcnt(6)
    s_add_u32 s7, s58, 0
    buffer_store_dwordx4 v[64:67], v255, s[12:15], s7 offen sc1
    s_waitcnt lgkmcnt(4)
    s_add_u32 s7, s58, 163840
    buffer_store_dwordx4 v[68:71], v255, s[12:15], s7 offen sc1
    s_waitcnt lgkmcnt(2)
    s_add_u32 s7, s58, 327680
    buffer_store_dwordx4 v[72:75], v255, s[12:15], s7 offen sc1
    s_waitcnt lgkmcnt(0)
    s_add_u32 s7, s58, 491520
    buffer_store_dwordx4 v[76:79], v255, s[12:15], s7 offen sc1
    s_lshl_b32 s6, s2, 7
    s_add_u32 s6, s6, 32768
    s_barrier
    s_cmp_lg_u32 s3, 0
    s_cbranch_scc1 Lnf_4
    v_mov_b32 v12, 0
    v_mov_b32 v10, s72
    v_mov_b32 v11, s0
    s_mov_b64 exec, 1
    buffer_store_dwordx2 v[10:11], v12, s[64:67], s6 offen sc1
    s_mov_b64 exec, -1
Lnf_4:
    s_bitcmp1_b32 s2, 7
    s_cselect_b32 s50, 4, 3
    s_mul_i32 s51, s50, 28672
    s_add_u32 s51, s51, s74
    s_mul_i32 s50, s50, 442368
    s_add_u32 m0, s51, 0
    s_mov_b32 s63, s50
    buffer_load_dwordx4 v248, s[52:55], s63 offen lds
    s_add_u32 m0, s51, 4096
    s_mov_b32 s63, s50
    buffer_load_dwordx4 v249, s[52:55], s63 offen lds
    s_add_u32 m0, s51, 8192
    s_mov_b32 s63, s50
    buffer_load_dwordx4 v250, s[52:55], s63 offen lds
    s_add_u32 m0, s51, 12288
    s_mov_b32 s63, s50
    buffer_load_dwordx4 v251, s[52:55], s63 offen lds
    s_add_u32 m0, s51, 16384
    s_mov_b32 s63, s50
    buffer_load_dwordx4 v252, s[52:55], s63 offen lds
    s_add_u32 m0, s51, 20480
    s_mov_b32 s63, s50
    buffer_load_dwordx4 v253, s[52:55], s63 offen lds
    s_add_u32 m0, s51, 24576
    s_mov_b32 s63, s50
    buffer_load_dwordx4 v254, s[52:55], s63 offen lds
    s_bitcmp1_b32 s2, 7
    s_cselect_b32 s50, 3, 4
    s_mul_i32 s51, s50, 28672
    s_add_u32 s51, s51, s74
    s_mul_i32 s50, s50, 442368
    s_add_u32 m0, s51, 0
    s_mov_b32 s63, s50
    buffer_load_dwordx4 v248, s[52:55], s63 offen lds
    s_add_u32 m0, s51, 4096
    s_mov_b32 s63, s50
    buffer_load_dwordx4 v249, s[52:55], s63 offen lds
    s_add_u32 m0, s51, 8192
    s_mov_b32 s63, s50
    buffer_load_dwordx4 v250, s[52:55], s63 offen lds
    s_add_u32 m0, s51, 12288
    s_mov_b32 s63, s50
    buffer_load_dwordx4 v251, s[52:55], s63 offen lds
    s_add_u32 m0, s51, 16384
    s_mov_b32 s63, s50
    buffer_load_dwordx4 v252, s[52:55], s63 offen lds
    s_add_u32 m0, s51, 20480
    s_mov_b32 s63, s50
    buffer_load_dwordx4 v253, s[52:55], s63 offen lds
    s_add_u32 m0, s51, 24576
    s_mov_b32 s63, s50
    buffer_load_dwordx4 v254, s[52:55], s63 offen lds
    s_waitcnt vmcnt(18)
    v_xor_b32 v208, s72, v208
    v_xor_b32 v210, s72, v210
    v_or_b32 v208, v208, v210
    v_cmp_ne_u32 vcc, 0, v208
    s_cbranch_vccz Lrpok_5
    s_mov_b64 s[32:33], -1
    s_mov_b64 s[34:35], -1
Lpoll_6:
    s_mov_b64 exec, s[32:33]
    s_cbranch_execz Lpq_8
    buffer_load_dwordx2 v[208:209], v45, s[64:67], s62 offen sc1
Lpq_8:
    s_mov_b64 exec, s[34:35]
    s_cbranch_execz Lpq_9
    buffer_load_dwordx2 v[210:211], v46, s[64:67], s62 offen sc1
Lpq_9:
    s_mov_b64 exec, -1
    s_waitcnt vmcnt(0)
    v_cmp_ne_u32 s[32:33], s72, v208
    v_cmp_ne_u32 s[34:35], s72, v210
    s_nop 1
    s_or_b64 vcc, s[32:33], s[34:35]
    s_sub_u32 s73, s73, 1
    s_cmp_lt_i32 s73, 0
    s_cbranch_scc1 Lto_10
    s_cbranch_vccnz Lpoll_6
Lto_10:
Lpollx_7:
Lrpok_5:
    s_branch L_COMMON
L_G1RETRY:
    s_sub_u32 s63, s63, 1
    s_cbranch_scc1 L_G1OK
    s_waitcnt vmcnt(0)
    s_branch L_G1
L_CSW:
    buffer_load_dwordx4 v[84:87], v5, s[64:67], s50 offen sc1
    s_waitcnt vmcnt(0)
    v_xor_b32 v85, s72, v85
    v_xor_b32 v87, s72, v87
    v_or_b32 v85, v85, v87
    v_cmp_ne_u32 vcc, 0, v85
    s_sub_u32 s73, s73, 1
    s_cmp_lt_i32 s73, 0
    s_cbranch_scc1 Lto_11
    s_cbranch_vccnz L_CSW
Lto_11:
    s_branch L_CSOK
L_SLOW1:
    s_mov_b64 exec, 1
    buffer_store_dword v14, v15, s[64:67], s61 offen sc1
    s_mov_b64 exec, -1
    v_and_b32 v9, 1, v3
    v_mul_u32_u24 v9, 65536, v9
    v_add_u32 v8, v8, v9
Ls1l_12:
    buffer_load_dword v12, v8, s[64:67], s47 offen sc1
    s_waitcnt vmcnt(0)
    v_cmp_ne_u32 vcc, s72, v12
    s_nop 1
    s_lshr_b32 s6, vcc_lo, 16
    s_and_b32 s6, vcc_lo, s6
    s_mov_b32 s7, 0
    s_mov_b64 vcc, s[6:7]
    s_sub_u32 s73, s73, 1
    s_cmp_lt_i32 s73, 0
    s_cbranch_scc1 Lto_13
    s_cbranch_vccnz Ls1l_12
Lto_13:
    s_branch L_SLOW1X
L_AUX3B:
    s_mov_b32 s73, 400000
    s_getreg_b32 s0, hwreg(HW_REG_XCC_ID, 0, 4)
    s_mov_b32 s68, s42
    s_mov_b32 s69, s43
    s_mov_b32 s70, 0x100
    s_mov_b32 s71, 0x20000
    s_mov_b32 s64, s44
    s_mov_b32 s65, s45
    s_mov_b32 s66, 0x28000
    s_mov_b32 s67, 0x20000
    s_sub_u32 s60, s2, 160
    s_mov_b32 s72, s4
    s_lshl_b32 s61, s60, 2
    s_add_u32 s61, s61, s3
    s_nop 0
    s_mul_i32 s62, s3, 5120
    s_add_u32 s62, s62, 143360
    s_mov_b32 s48, 1120
    v_add_u32 v4, 0, v1
    v_mul_u32_u24 v3, 6554, v4
    v_lshrrev_b32 v3, 16, v3
    v_lshlrev_b32 v4, 4, v4
    v_mad_u32_u24 v64, v3, s48, v4
    v_add_u32 v4, 64, v1
    v_mul_u32_u24 v3, 6554, v4
    v_lshrrev_b32 v3, 16, v3
    v_lshlrev_b32 v4, 4, v4
    v_mad_u32_u24 v65, v3, s48, v4
    v_add_u32 v4, 128, v1
    v_mul_u32_u24 v3, 6554, v4
    v_lshrrev_b32 v3, 16, v3
    v_lshlrev_b32 v4, 4, v4
    v_mad_u32_u24 v66, v3, s48, v4
    v_add_u32 v4, 192, v1
    v_mul_u32_u24 v3, 6554, v4
    v_lshrrev_b32 v3, 16, v3
    v_lshlrev_b32 v4, 4, v4
    v_mad_u32_u24 v67, v3, s48, v4
    v_add_u32 v4, 256, v1
    v_mul_u32_u24 v3, 6554, v4
    v_lshrrev_b32 v3, 16, v3
    v_lshlrev_b32 v4, 4, v4
    v_mad_u32_u24 v68, v3, s48, v4
    v_lshrrev_b32 v4, 2, v1
    v_mul_u32_u24 v4, 160, v4
    v_and_b32 v3, 3, v1
    v_lshl_add_u32 v69, v3, 3, v4
    s_mov_b32 s24, s38
    s_mov_b32 s25, s39
    s_mov_b32 s26, 0x21c000
    s_mov_b32 s27, 0x20000
    s_mov_b32 s28, s36
    s_mov_b32 s29, s37
    s_mov_b32 s30, 0x21c000
    s_mov_b32 s31, 0x20000
    v_and_b32 v71, 3, v1
    v_lshlrev_b32 v71, 10, v71
    s_waitcnt vmcnt(6)
    v_readfirstlane_b32 s6, v12
    s_nop 1
    s_cmp_eq_u32 s6, 0
    s_cselect_b32 s72, s72, s6
    v_mov_b32 v13, s72
    ds_write_b32 v71, v13
    s_waitcnt lgkmcnt(0)
    s_barrier
    s_mov_b32 s48, 3232
    s_and_b32 s49, s2, 7
    s_lshl_b32 s49, s49, 4
    s_add_u32 s49, s49, s2
    s_bfe_u32 s49, s49, 0x40003
    s_bitcmp1_b32 s49, 0
    s_cselect_b32 s49, 0, 208
    v_mov_b32 v231, 1048576
    v_add_u32 v4, 0, v0
    v_mul_u32_u24 v5, 4682, v4
    v_lshrrev_b32 v5, 16, v5
    v_lshlrev_b32 v4, 4, v4
    v_mad_u32_u24 v248, v5, s48, v4
    v_mul_u32_u24 v5, 224, v5
    v_sub_u32 v5, v4, v5
    v_cmp_eq_u32 vcc, s49, v5
    s_nop 1
    v_cndmask_b32 v231, v231, v4, vcc
    v_add_u32 v4, 256, v0
    v_mul_u32_u24 v5, 4682, v4
    v_lshrrev_b32 v5, 16, v5
    v_lshlrev_b32 v4, 4, v4
    v_mad_u32_u24 v249, v5, s48, v4
    v_mul_u32_u24 v5, 224, v5
    v_sub_u32 v5, v4, v5
    v_cmp_eq_u32 vcc, s49, v5
    s_nop 1
    v_cndmask_b32 v231, v231, v4, vcc
    v_add_u32 v4, 512, v0
    v_mul_u32_u24 v5, 4682, v4
    v_lshrrev_b32 v5, 16, v5
    v_lshlrev_b32 v4, 4, v4
    v_mad_u32_u24 v250, v5, s48, v4
    v_mul_u32_u24 v5, 224, v5
    v_sub_u32 v5, v4, v5
    v_cmp_eq_u32 vcc, s49, v5
    s_nop 1
    v_cndmask_b32 v231, v231, v4, vcc
    v_add_u32 v4, 768, v0
    v_mul_u32_u24 v5, 4682, v4
    v_lshrrev_b32 v5, 16, v5
    v_lshlrev_b32 v4, 4, v4
    v_mad_u32_u24 v251, v5, s48, v4
    v_mul_u32_u24 v5, 224, v5
    v_sub_u32 v5, v4, v5
    v_cmp_eq_u32 vcc, s49, v5
    s_nop 1
    v_cndmask_b32 v231, v231, v4, vcc
    v_add_u32 v4, 1024, v0
    v_mul_u32_u24 v5, 4682, v4
    v_lshrrev_b32 v5, 16, v5
    v_lshlrev_b32 v4, 4, v4
    v_mad_u32_u24 v252, v5, s48, v4
    v_mul_u32_u24 v5, 224, v5
    v_sub_u32 v5, v4, v5
    v_cmp_eq_u32 vcc, s49, v5
    s_nop 1
    v_cndmask_b32 v231, v231, v4, vcc
    v_add_u32 v4, 1280, v0
    v_mul_u32_u24 v5, 4682, v4
    v_lshrrev_b32 v5, 16, v5
    v_lshlrev_b32 v4, 4, v4
    v_mad_u32_u24 v253, v5, s48, v4
    v_mul_u32_u24 v5, 224, v5
    v_sub_u32 v5, v4, v5
    v_cmp_eq_u32 vcc, s49, v5
    s_nop 1
    v_cndmask_b32 v231, v231, v4, vcc
    v_add_u32 v4, 1536, v0
    v_mul_u32_u24 v5, 4682, v4
    v_lshrrev_b32 v5, 16, v5
    v_lshlrev_b32 v4, 4, v4
    v_mad_u32_u24 v254, v5, s48, v4
    v_mul_u32_u24 v5, 224, v5
    v_sub_u32 v5, v4, v5
    v_cmp_eq_u32 vcc, s49, v5
    s_nop 1
    v_cndmask_b32 v231, v231, v4, vcc
    s_add_u32 s12, s44, 0x100000
    s_addc_u32 s13, s45, 0
    s_mov_b32 s14, 0x21c000
    s_mov_b32 s15, 0x20000
    s_and_b32 s4, s61, 7
    s_lshr_b32 s5, s61, 3
    s_mul_i32 s6, s5, 40960
    s_mul_i32 s7, s4, 160
    s_add_u32 s6, s6, s7
    s_nop 0
    buffer_load_dwordx4 v[104:107], v64, s[24:27], s6 offen
    buffer_load_dwordx4 v[108:111], v65, s[24:27], s6 offen
    buffer_load_dwordx4 v[112:115], v66, s[24:27], s6 offen
    buffer_load_dwordx4 v[116:119], v67, s[24:27], s6 offen
    buffer_load_dwordx4 v[120:123], v68, s[24:27], s6 offen
    s_add_u32 s56, s60, 384
    s_and_b32 s58, s56, 7
    s_lshr_b32 s59, s56, 3
    s_mul_i32 s6, s59, 40960
    s_mul_i32 s7, s58, 160
    s_add_u32 s6, s6, s7
    s_nop 0
    buffer_load_dwordx4 v[72:75], v64, s[24:27], s6 offen
    buffer_load_dwordx4 v[76:79], v65, s[24:27], s6 offen
    buffer_load_dwordx4 v[80:83], v66, s[24:27], s6 offen
    buffer_load_dwordx4 v[84:87], v67, s[24:27], s6 offen
    buffer_load_dwordx4 v[88:91], v68, s[24:27], s6 offen
    v_lshl_add_u32 v4, v1, 4, s62
    v_add_u32 v5, s62, v69
    v_lshlrev_b32 v7, 4, v1
    s_mul_i32 s49, s4, 54
    s_add_u32 s49, s49, s5
    s_mul_i32 s49, s49, 5120
    s_add_u32 s50, s49, 4096
    s_waitcnt vmcnt(9)
    ds_write_b128 v4, v[104:107] offset:0
    s_waitcnt vmcnt(8)
    ds_write_b128 v4, v[108:111] offset:1024
    s_waitcnt vmcnt(7)
    ds_write_b128 v4, v[112:115] offset:2048
    s_waitcnt vmcnt(6)
    ds_write_b128 v4, v[116:119] offset:3072
    s_waitcnt vmcnt(5)
    s_nop 0
    ds_write_b128 v4, v[120:123] offset:4096
    ds_read_b64_tr_b16 v[104:105], v5 offset:0
    ds_read_b64_tr_b16 v[106:107], v5 offset:2560
    ds_read_b64_tr_b16 v[108:109], v5 offset:32
    ds_read_b64_tr_b16 v[110:111], v5 offset:2592
    ds_read_b64_tr_b16 v[112:113], v5 offset:64
    ds_read_b64_tr_b16 v[114:115], v5 offset:2624
    ds_read_b64_tr_b16 v[116:117], v5 offset:96
    ds_read_b64_tr_b16 v[118:119], v5 offset:2656
    ds_read_b64_tr_b16 v[120:121], v5 offset:128
    ds_read_b64_tr_b16 v[122:123], v5 offset:2688
    s_waitcnt lgkmcnt(8)
    buffer_store_dwordx4 v[104:107], v7, s[12:15], s49 offen offset:0 sc1
    s_waitcnt lgkmcnt(6)
    buffer_store_dwordx4 v[108:111], v7, s[12:15], s49 offen offset:1024 sc1
    s_waitcnt lgkmcnt(4)
    buffer_store_dwordx4 v[112:115], v7, s[12:15], s49 offen offset:2048 sc1
    s_waitcnt lgkmcnt(2)
    buffer_store_dwordx4 v[116:119], v7, s[12:15], s49 offen offset:3072 sc1
    s_waitcnt lgkmcnt(0)
    buffer_store_dwordx4 v[120:123], v7, s[12:15], s50 offen offset:0 sc1
    s_cmp_ge_u32 s56, 432
    s_cbranch_scc1 Laj_14
    v_lshl_add_u32 v4, v1, 4, s62
    v_add_u32 v5, s62, v69
    v_lshlrev_b32 v7, 4, v1
    s_mul_i32 s49, s58, 54
    s_add_u32 s49, s49, s59
    s_mul_i32 s49, s49, 5120
    s_add_u32 s50, s49, 4096
    s_waitcnt vmcnt(9)
    ds_write_b128 v4, v[72:75] offset:0
    s_waitcnt vmcnt(8)
    ds_write_b128 v4, v[76:79] offset:1024
    s_waitcnt vmcnt(7)
    ds_write_b128 v4, v[80:83] offset:2048
    s_waitcnt vmcnt(6)
    ds_write_b128 v4, v[84:87] offset:3072
    s_waitcnt vmcnt(5)
    s_nop 0
    ds_write_b128 v4, v[88:91] offset:4096
    ds_read_b64_tr_b16 v[72:73], v5 offset:0
    ds_read_b64_tr_b16 v[74:75], v5 offset:2560
    ds_read_b64_tr_b16 v[76:77], v5 offset:32
    ds_read_b64_tr_b16 v[78:79], v5 offset:2592
    ds_read_b64_tr_b16 v[80:81], v5 offset:64
    ds_read_b64_tr_b16 v[82:83], v5 offset:2624
    ds_read_b64_tr_b16 v[84:85], v5 offset:96
    ds_read_b64_tr_b16 v[86:87], v5 offset:2656
    ds_read_b64_tr_b16 v[88:89], v5 offset:128
    ds_read_b64_tr_b16 v[90:91], v5 offset:2688
    s_waitcnt lgkmcnt(8)
    buffer_store_dwordx4 v[72:75], v7, s[12:15], s49 offen offset:0 sc1
    s_waitcnt lgkmcnt(6)
    buffer_store_dwordx4 v[76:79], v7, s[12:15], s49 offen offset:1024 sc1
    s_waitcnt lgkmcnt(4)
    buffer_store_dwordx4 v[80:83], v7, s[12:15], s49 offen offset:2048 sc1
    s_waitcnt lgkmcnt(2)
    buffer_store_dwordx4 v[84:87], v7, s[12:15], s49 offen offset:3072 sc1
    s_waitcnt lgkmcnt(0)
    buffer_store_dwordx4 v[88:91], v7, s[12:15], s50 offen offset:0 sc1
Laj_14:
    s_branch L_AUXJ
L_AUX:
    s_mov_b32 s73, 400000
    s_getreg_b32 s0, hwreg(HW_REG_XCC_ID, 0, 4)
    s_mov_b32 s68, s42
    s_mov_b32 s69, s43
    s_mov_b32 s70, 0x100
    s_mov_b32 s71, 0x20000
    s_mov_b32 s64, s44
    s_mov_b32 s65, s45
    s_mov_b32 s66, 0x28000
    s_mov_b32 s67, 0x20000
    s_lshl_b32 s61, s60, 2
    s_add_u32 s61, s61, s3
    s_nop 0
    s_mul_i32 s62, s3, 5120
    s_add_u32 s62, s62, 143360
    s_mov_b32 s48, 1120
    v_add_u32 v4, 0, v1
    v_mul_u32_u24 v3, 6554, v4
    v_lshrrev_b32 v3, 16, v3
    v_lshlrev_b32 v4, 4, v4
    v_mad_u32_u24 v64, v3, s48, v4
    v_add_u32 v4, 64, v1
    v_mul_u32_u24 v3, 6554, v4
    v_lshrrev_b32 v3, 16, v3
    v_lshlrev_b32 v4, 4, v4
    v_mad_u32_u24 v65, v3, s48, v4
    v_add_u32 v4, 128, v1
    v_mul_u32_u24 v3, 6554, v4
    v_lshrrev_b32 v3, 16, v3
    v_lshlrev_b32 v4, 4, v4
    v_mad_u32_u24 v66, v3, s48, v4
    v_add_u32 v4, 192, v1
    v_mul_u32_u24 v3, 6554, v4
    v_lshrrev_b32 v3, 16, v3
    v_lshlrev_b32 v4, 4, v4
    v_mad_u32_u24 v67, v3, s48, v4
    v_add_u32 v4, 256, v1
    v_mul_u32_u24 v3, 6554, v4
    v_lshrrev_b32 v3, 16, v3
    v_lshlrev_b32 v4, 4, v4
    v_mad_u32_u24 v68, v3, s48, v4
    v_lshrrev_b32 v4, 2, v1
    v_mul_u32_u24 v4, 160, v4
    v_and_b32 v3, 3, v1
    v_lshl_add_u32 v69, v3, 3, v4
    s_mov_b32 s24, s38
    s_mov_b32 s25, s39
    s_mov_b32 s26, 0x21c000
    s_mov_b32 s27, 0x20000
    s_mov_b32 s28, s36
    s_mov_b32 s29, s37
    s_mov_b32 s30, 0x21c000
    s_mov_b32 s31, 0x20000
    s_lshl_b32 s6, s3, 10
    v_mov_b32 v71, s6
    s_mov_b32 s48, 3232
    s_and_b32 s49, s2, 7
    s_lshl_b32 s49, s49, 4
    s_add_u32 s49, s49, s2
    s_bfe_u32 s49, s49, 0x40003
    s_bitcmp1_b32 s49, 0
    s_cselect_b32 s49, 0, 208
    v_mov_b32 v231, 1048576
    v_add_u32 v4, 0, v0
    v_mul_u32_u24 v5, 4682, v4
    v_lshrrev_b32 v5, 16, v5
    v_lshlrev_b32 v4, 4, v4
    v_mad_u32_u24 v248, v5, s48, v4
    v_mul_u32_u24 v5, 224, v5
    v_sub_u32 v5, v4, v5
    v_cmp_eq_u32 vcc, s49, v5
    s_nop 1
    v_cndmask_b32 v231, v231, v4, vcc
    v_add_u32 v4, 256, v0
    v_mul_u32_u24 v5, 4682, v4
    v_lshrrev_b32 v5, 16, v5
    v_lshlrev_b32 v4, 4, v4
    v_mad_u32_u24 v249, v5, s48, v4
    v_mul_u32_u24 v5, 224, v5
    v_sub_u32 v5, v4, v5
    v_cmp_eq_u32 vcc, s49, v5
    s_nop 1
    v_cndmask_b32 v231, v231, v4, vcc
    v_add_u32 v4, 512, v0
    v_mul_u32_u24 v5, 4682, v4
    v_lshrrev_b32 v5, 16, v5
    v_lshlrev_b32 v4, 4, v4
    v_mad_u32_u24 v250, v5, s48, v4
    v_mul_u32_u24 v5, 224, v5
    v_sub_u32 v5, v4, v5
    v_cmp_eq_u32 vcc, s49, v5
    s_nop 1
    v_cndmask_b32 v231, v231, v4, vcc
    v_add_u32 v4, 768, v0
    v_mul_u32_u24 v5, 4682, v4
    v_lshrrev_b32 v5, 16, v5
    v_lshlrev_b32 v4, 4, v4
    v_mad_u32_u24 v251, v5, s48, v4
    v_mul_u32_u24 v5, 224, v5
    v_sub_u32 v5, v4, v5
    v_cmp_eq_u32 vcc, s49, v5
    s_nop 1
    v_cndmask_b32 v231, v231, v4, vcc
    v_add_u32 v4, 1024, v0
    v_mul_u32_u24 v5, 4682, v4
    v_lshrrev_b32 v5, 16, v5
    v_lshlrev_b32 v4, 4, v4
    v_mad_u32_u24 v252, v5, s48, v4
    v_mul_u32_u24 v5, 224, v5
    v_sub_u32 v5, v4, v5
    v_cmp_eq_u32 vcc, s49, v5
    s_nop 1
    v_cndmask_b32 v231, v231, v4, vcc
    v_add_u32 v4, 1280, v0
    v_mul_u32_u24 v5, 4682, v4
    v_lshrrev_b32 v5, 16, v5
    v_lshlrev_b32 v4, 4, v4
    v_mad_u32_u24 v253, v5, s48, v4
    v_mul_u32_u24 v5, 224, v5
    v_sub_u32 v5, v4, v5
    v_cmp_eq_u32 vcc, s49, v5
    s_nop 1
    v_cndmask_b32 v231, v231, v4, vcc
    v_add_u32 v4, 1536, v0
    v_mul_u32_u24 v5, 4682, v4
    v_lshrrev_b32 v5, 16, v5
    v_lshlrev_b32 v4, 4, v4
    v_mad_u32_u24 v254, v5, s48, v4
    v_mul_u32_u24 v5, 224, v5
    v_sub_u32 v5, v4, v5
    v_cmp_eq_u32 vcc, s49, v5
    s_nop 1
    v_cndmask_b32 v231, v231, v4, vcc
    s_add_u32 s12, s44, 0x100000
    s_addc_u32 s13, s45, 0
    s_mov_b32 s14, 0x21c000
    s_mov_b32 s15, 0x20000
    s_mov_b32 s46, 0x3f803f80
    s_waitcnt vmcnt(9)
    s_nop 0
    v_dot2_f32_bf16 v8, v16, s46, 0
    v_dot2_f32_bf16 v10, v16, v16, 0
    v_dot2_f32_bf16 v9, v17, s46, 0
    v_dot2_f32_bf16 v11, v17, v17, 0
    v_dot2_f32_bf16 v8, v18, s46, v8
    v_dot2_f32_bf16 v10, v18, v18, v10
    v_dot2_f32_bf16 v9, v19, s46, v9
    v_dot2_f32_bf16 v11, v19, v19, v11
    s_waitcnt vmcnt(8)
    s_nop 0
    v_dot2_f32_bf16 v8, v20, s46, v8
    v_dot2_f32_bf16 v10, v20, v20, v10
    v_dot2_f32_bf16 v9, v21, s46, v9
    v_dot2_f32_bf16 v11, v21, v21, v11
    v_dot2_f32_bf16 v8, v22, s46, v8
    v_dot2_f32_bf16 v10, v22, v22, v10
    v_dot2_f32_bf16 v9, v23, s46, v9
    v_dot2_f32_bf16 v11, v23, v23, v11
    s_waitcnt vmcnt(7)
    s_nop 0
    v_dot2_f32_bf16 v8, v24, s46, v8
    v_dot2_f32_bf16 v10, v24, v24, v10
    v_dot2_f32_bf16 v9, v25, s46, v9
    v_dot2_f32_bf16 v11, v25, v25, v11
    v_dot2_f32_bf16 v8, v26, s46, v8
    v_dot2_f32_bf16 v10, v26, v26, v10
    v_dot2_f32_bf16 v9, v27, s46, v9
    v_dot2_f32_bf16 v11, v27, v27, v11
    s_waitcnt vmcnt(6)
    s_nop 0
    v_dot2_f32_bf16 v8, v28, s46, v8
    v_dot2_f32_bf16 v10, v28, v28, v10
    v_dot2_f32_bf16 v9, v29, s46, v9
    v_dot2_f32_bf16 v11, v29, v29, v11
    v_dot2_f32_bf16 v8, v30, s46, v8
    v_dot2_f32_bf16 v10, v30, v30, v10
    v_dot2_f32_bf16 v9, v31, s46, v9
    v_dot2_f32_bf16 v11, v31, v31, v11
    s_waitcnt vmcnt(5)
    s_nop 0
    v_dot2_f32_bf16 v8, v32, s46, v8
    v_dot2_f32_bf16 v10, v32, v32, v10
    v_dot2_f32_bf16 v9, v33, s46, v9
    v_dot2_f32_bf16 v11, v33, v33, v11
    v_dot2_f32_bf16 v8, v34, s46, v8
    v_dot2_f32_bf16 v10, v34, v34, v10
    v_dot2_f32_bf16 v9, v35, s46, v9
    v_dot2_f32_bf16 v11, v35, v35, v11
    s_waitcnt vmcnt(4)
    s_nop 0
    v_dot2_f32_bf16 v8, v36, s46, v8
    v_dot2_f32_bf16 v10, v36, v36, v10
    v_dot2_f32_bf16 v9, v37, s46, v9
    v_dot2_f32_bf16 v11, v37, v37, v11
    v_dot2_f32_bf16 v8, v38, s46, v8
    v_dot2_f32_bf16 v10, v38, v38, v10
    v_dot2_f32_bf16 v9, v39, s46, v9
    v_dot2_f32_bf16 v11, v39, v39, v11
    s_waitcnt vmcnt(3)
    s_nop 0
    v_dot2_f32_bf16 v8, v40, s46, v8
    v_dot2_f32_bf16 v10, v40, v40, v10
    v_dot2_f32_bf16 v9, v41, s46, v9
    v_dot2_f32_bf16 v11, v41, v41, v11
    v_dot2_f32_bf16 v8, v42, s46, v8
    v_dot2_f32_bf16 v10, v42, v42, v10
    v_dot2_f32_bf16 v9, v43, s46, v9
    v_dot2_f32_bf16 v11, v43, v43, v11
    s_waitcnt vmcnt(2)
    s_nop 0
    v_dot2_f32_bf16 v8, v44, s46, v8
    v_dot2_f32_bf16 v10, v44, v44, v10
    v_dot2_f32_bf16 v9, v45, s46, v9
    v_dot2_f32_bf16 v11, v45, v45, v11
    v_dot2_f32_bf16 v8, v46, s46, v8
    v_dot2_f32_bf16 v10, v46, v46, v10
    v_dot2_f32_bf16 v9, v47, s46, v9
    v_dot2_f32_bf16 v11, v47, v47, v11
    s_waitcnt vmcnt(1)
    s_nop 0
    v_dot2_f32_bf16 v8, v48, s46, v8
    v_dot2_f32_bf16 v10, v48, v48, v10
    v_dot2_f32_bf16 v9, v49, s46, v9
    v_dot2_f32_bf16 v11, v49, v49, v11
    v_dot2_f32_bf16 v8, v50, s46, v8
    v_dot2_f32_bf16 v10, v50, v50, v10
    v_dot2_f32_bf16 v9, v51, s46, v9
    v_dot2_f32_bf16 v11, v51, v51, v11
    s_waitcnt vmcnt(0)
    s_nop 0
    v_dot2_f32_bf16 v8, v52, s46, v8
    v_dot2_f32_bf16 v10, v52, v52, v10
    v_dot2_f32_bf16 v9, v53, s46, v9
    v_dot2_f32_bf16 v11, v53, v53, v11
    v_dot2_f32_bf16 v8, v54, s46, v8
    v_dot2_f32_bf16 v10, v54, v54, v10
    v_dot2_f32_bf16 v9, v55, s46, v9
    v_dot2_f32_bf16 v11, v55, v55, v11
    s_barrier
    ds_read_b32 v15, v71
    v_add_f32 v8, v8, v9
    v_add_f32 v10, v10, v11
    s_nop 0
    v_add_f32_dpp v8, v8, v8 quad_perm:[1,0,3,2] row_mask:0xf bank_mask:0xf
    v_add_f32_dpp v10, v10, v10 quad_perm:[1,0,3,2] row_mask:0xf bank_mask:0xf
    s_nop 0
    v_add_f32_dpp v8, v8, v8 quad_perm:[2,3,0,1] row_mask:0xf bank_mask:0xf
    v_add_f32_dpp v10, v10, v10 quad_perm:[2,3,0,1] row_mask:0xf bank_mask:0xf
    s_nop 0
    v_add_f32_dpp v8, v8, v8 row_half_mirror row_mask:0xf bank_mask:0xf
    v_add_f32_dpp v10, v10, v10 row_half_mirror row_mask:0xf bank_mask:0xf
    v_mul_f32 v8, 0x3acccccd, v8
    v_mul_f32 v10, 0x3acccccd, v10
    v_fma_f32 v10, -v8, v8, v10
    v_max_f32 v10, 0, v10
    v_cvt_pk_bf16_f32 v9, v10, v10
    v_lshlrev_b32 v10, 16, v9
    v_add_f32 v10, 0x3727c5ac, v10
    v_cvt_pk_bf16_f32 v9, v10, v10
    v_lshlrev_b32 v10, 16, v9
    v_sqrt_f32 v10, v10
    s_nop 0
    v_cvt_pk_bf16_f32 v14, v8, v10
    v_and_b32 v3, 7, v1
    v_cmp_eq_u32 vcc, 0, v3
    v_mov_b32 v9, 0x40000000
    s_nop 0
    v_cndmask_b32 v9, v9, v1, vcc
    s_lshl_b32 s6, s57, 6
    s_cmp_ge_u32 s57, 256
    s_cselect_b32 s6, 0x40000000, s6
    s_waitcnt lgkmcnt(0)
    buffer_store_dwordx2 v[14:15], v9, s[64:67], s6 offen sc1
    v_readfirstlane_b32 s72, v15
    s_and_b32 s4, s61, 7
    s_lshr_b32 s5, s61, 3
    s_mul_i32 s6, s5, 40960
    s_mul_i32 s7, s4, 160
    s_add_u32 s6, s6, s7
    s_nop 0
    buffer_load_dwordx4 v[104:107], v64, s[24:27], s6 offen
    buffer_load_dwordx4 v[108:111], v65, s[24:27], s6 offen
    buffer_load_dwordx4 v[112:115], v66, s[24:27], s6 offen
    buffer_load_dwordx4 v[116:119], v67, s[24:27], s6 offen
    buffer_load_dwordx4 v[120:123], v68, s[24:27], s6 offen
    v_lshl_add_u32 v4, v1, 4, s62
    v_add_u32 v5, s62, v69
    v_lshlrev_b32 v7, 4, v1
    s_mul_i32 s49, s4, 54
    s_add_u32 s49, s49, s5
    s_mul_i32 s49, s49, 5120
    s_add_u32 s50, s49, 4096
    s_waitcnt vmcnt(4)
    ds_write_b128 v4, v[104:107] offset:0
    s_waitcnt vmcnt(3)
    ds_write_b128 v4, v[108:111] offset:1024
    s_waitcnt vmcnt(2)
    ds_write_b128 v4, v[112:115] offset:2048
    s_waitcnt vmcnt(1)
    ds_write_b128 v4, v[116:119] offset:3072
    s_waitcnt vmcnt(0)
    s_nop 0
    ds_write_b128 v4, v[120:123] offset:4096
    ds_read_b64_tr_b16 v[104:105], v5 offset:0
    ds_read_b64_tr_b16 v[106:107], v5 offset:2560
    ds_read_b64_tr_b16 v[108:109], v5 offset:32
    ds_read_b64_tr_b16 v[110:111], v5 offset:2592
    ds_read_b64_tr_b16 v[112:113], v5 offset:64
    ds_read_b64_tr_b16 v[114:115], v5 offset:2624
    ds_read_b64_tr_b16 v[116:117], v5 offset:96
    ds_read_b64_tr_b16 v[118:119], v5 offset:2656
    ds_read_b64_tr_b16 v[120:121], v5 offset:128
    ds_read_b64_tr_b16 v[122:123], v5 offset:2688
    s_waitcnt lgkmcnt(8)
    buffer_store_dwordx4 v[104:107], v7, s[12:15], s49 offen offset:0 sc1
    s_waitcnt lgkmcnt(6)
    buffer_store_dwordx4 v[108:111], v7, s[12:15], s49 offen offset:1024 sc1
    s_waitcnt lgkmcnt(4)
    buffer_store_dwordx4 v[112:115], v7, s[12:15], s49 offen offset:2048 sc1
    s_waitcnt lgkmcnt(2)
    buffer_store_dwordx4 v[116:119], v7, s[12:15], s49 offen offset:3072 sc1
    s_waitcnt lgkmcnt(0)
    buffer_store_dwordx4 v[120:123], v7, s[12:15], s50 offen offset:0 sc1
L_AUXJ:
    v_lshlrev_b32 v6, 7, v1
    s_lshl_b32 s6, s61, 13
    buffer_load_dword v238, v6, s[28:31], s6 offen
    s_and_b32 s6, s2, 7
    s_lshl_b32 s6, s6, 4
    s_add_u32 s6, s6, s2
    s_bfe_u32 s6, s6, 0x40003
    s_mul_i32 s6, s6, 216
    s_and_b32 s75, s6, 15
    s_sub_u32 s6, s6, s75
    s_add_u32 s52, s36, s6
    s_addc_u32 s53, s37, 0
    s_sub_u32 s54, 2211840, s6
    s_mov_b32 s55, 0x20000
    s_lshl_b32 s74, s3, 10
    v_mov_b32 v31, v231
    s_waitcnt vmcnt(1)
    s_barrier
    s_lshl_b32 s6, s60, 7
    s_add_u32 s6, s6, 16384
    s_cmp_lg_u32 s3, 0
    s_cbranch_scc1 Lnf_15
    v_mov_b32 v12, 0
    v_mov_b32 v10, s72
    v_mov_b32 v11, s0
    s_mov_b64 exec, 1
    buffer_store_dwordx2 v[10:11], v12, s[64:67], s6 offen sc1
    s_mov_b64 exec, -1
Lnf_15:
    s_bitcmp1_b32 s2, 7
    s_cselect_b32 s50, 3, 0
    s_mul_i32 s51, s50, 28672
    s_add_u32 s51, s51, s74
    s_mul_i32 s50, s50, 442368
    s_add_u32 m0, s51, 0
    s_mov_b32 s63, s50
    buffer_load_dwordx4 v248, s[52:55], s63 offen lds
    s_add_u32 m0, s51, 4096
    s_mov_b32 s63, s50
    buffer_load_dwordx4 v249, s[52:55], s63 offen lds
    s_add_u32 m0, s51, 8192
    s_mov_b32 s63, s50
    buffer_load_dwordx4 v250, s[52:55], s63 offen lds
    s_add_u32 m0, s51, 12288
    s_mov_b32 s63, s50
    buffer_load_dwordx4 v251, s[52:55], s63 offen lds
    s_add_u32 m0, s51, 16384
    s_mov_b32 s63, s50
    buffer_load_dwordx4 v252, s[52:55], s63 offen lds
    s_add_u32 m0, s51, 20480
    s_mov_b32 s63, s50
    buffer_load_dwordx4 v253, s[52:55], s63 offen lds
    s_add_u32 m0, s51, 24576
    s_mov_b32 s63, s50
    buffer_load_dwordx4 v254, s[52:55], s63 offen lds
    s_bitcmp1_b32 s2, 7
    s_cselect_b32 s50, 4, 1
    s_mul_i32 s51, s50, 28672
    s_add_u32 s51, s51, s74
    s_mul_i32 s50, s50, 442368
    s_add_u32 m0, s51, 0
    s_mov_b32 s63, s50
    buffer_load_dwordx4 v248, s[52:55], s63 offen lds
    s_add_u32 m0, s51, 4096
    s_mov_b32 s63, s50
    buffer_load_dwordx4 v249, s[52:55], s63 offen lds
    s_add_u32 m0, s51, 8192
    s_mov_b32 s63, s50
    buffer_load_dwordx4 v250, s[52:55], s63 offen lds
    s_add_u32 m0, s51, 12288
    s_mov_b32 s63, s50
    buffer_load_dwordx4 v251, s[52:55], s63 offen lds
    s_add_u32 m0, s51, 16384
    s_mov_b32 s63, s50
    buffer_load_dwordx4 v252, s[52:55], s63 offen lds
    s_add_u32 m0, s51, 20480
    s_mov_b32 s63, s50
    buffer_load_dwordx4 v253, s[52:55], s63 offen lds
    s_add_u32 m0, s51, 24576
    s_mov_b32 s63, s50
    buffer_load_dwordx4 v254, s[52:55], s63 offen lds
    s_add_u32 m0, s74, 57344
    s_mov_b32 s63, 884736
    buffer_load_dwordx4 v248, s[52:55], s63 offen lds
    s_add_u32 m0, s74, 61440
    s_mov_b32 s63, 884736
    buffer_load_dwordx4 v249, s[52:55], s63 offen lds
    s_add_u32 m0, s74, 65536
    s_mov_b32 s63, 884736
    buffer_load_dwordx4 v250, s[52:55], s63 offen lds
    s_add_u32 m0, s74, 69632
    s_mov_b32 s63, 884736
    buffer_load_dwordx4 v251, s[52:55], s63 offen lds
    s_add_u32 m0, s74, 73728
    s_mov_b32 s63, 884736
    buffer_load_dwordx4 v252, s[52:55], s63 offen lds
    s_add_u32 m0, s74, 77824
    s_mov_b32 s63, 884736
    buffer_load_dwordx4 v253, s[52:55], s63 offen lds
    s_add_u32 m0, s74, 81920
    s_mov_b32 s63, 884736
    buffer_load_dwordx4 v254, s[52:55], s63 offen lds
    s_bitcmp1_b32 s2, 7
    s_cselect_b32 s50, 0, 3
    s_mul_i32 s51, s50, 28672
    s_add_u32 s51, s51, s74
    s_mul_i32 s50, s50, 442368
    s_add_u32 m0, s51, 0
    s_mov_b32 s63, s50
    buffer_load_dwordx4 v248, s[52:55], s63 offen lds
    s_add_u32 m0, s51, 4096
    s_mov_b32 s63, s50
    buffer_load_dwordx4 v249, s[52:55], s63 offen lds
    s_add_u32 m0, s51, 8192
    s_mov_b32 s63, s50
    buffer_load_dwordx4 v250, s[52:55], s63 offen lds
    s_add_u32 m0, s51, 12288
    s_mov_b32 s63, s50
    buffer_load_dwordx4 v251, s[52:55], s63 offen lds
    s_add_u32 m0, s51, 16384
    s_mov_b32 s63, s50
    buffer_load_dwordx4 v252, s[52:55], s63 offen lds
    s_add_u32 m0, s51, 20480
    s_mov_b32 s63, s50
    buffer_load_dwordx4 v253, s[52:55], s63 offen lds
    s_add_u32 m0, s51, 24576
    s_mov_b32 s63, s50
    buffer_load_dwordx4 v254, s[52:55], s63 offen lds
    s_bitcmp1_b32 s2, 7
    s_cselect_b32 s50, 1, 4
    s_mul_i32 s51, s50, 28672
    s_add_u32 s51, s51, s74
    s_mul_i32 s50, s50, 442368
    s_add_u32 m0, s51, 0
    s_mov_b32 s63, s50
    buffer_load_dwordx4 v248, s[52:55], s63 offen lds
    s_add_u32 m0, s51, 4096
    s_mov_b32 s63, s50
    buffer_load_dwordx4 v249, s[52:55], s63 offen lds
    s_add_u32 m0, s51, 8192
    s_mov_b32 s63, s50
    buffer_load_dwordx4 v250, s[52:55], s63 offen lds
    s_add_u32 m0, s51, 12288
    s_mov_b32 s63, s50
    buffer_load_dwordx4 v251, s[52:55], s63 offen lds
    s_add_u32 m0, s51, 16384
    s_mov_b32 s63, s50
    buffer_load_dwordx4 v252, s[52:55], s63 offen lds
    s_add_u32 m0, s51, 20480
    s_mov_b32 s63, s50
    buffer_load_dwordx4 v253, s[52:55], s63 offen lds
    s_add_u32 m0, s51, 24576
    s_mov_b32 s63, s50
    buffer_load_dwordx4 v254, s[52:55], s63 offen lds
    s_lshr_b32 s5, s60, 3
    s_mul_i32 s5, s5, 24576
    v_min_u32 v2, 191, v0
    v_lshlrev_b32 v2, 7, v2
    s_add_u32 s6, s5, 1327104
    buffer_load_dword v239, v2, s[28:31], s6 offen
    s_add_u32 s6, s5, 1622016
    buffer_load_dword v239, v2, s[28:31], s6 offen
    s_add_u32 s6, s5, 1916928
    buffer_load_dword v239, v2, s[28:31], s6 offen
    s_cmp_lt_u32 s60, 80
    s_cbranch_scc1 Lnocs_16
    v_lshrrev_b32 v6, 2, v1
    v_mul_u32_u24 v6, 224, v6
    v_and_b32 v7, 3, v1
    v_lshl_add_u32 v6, v7, 3, v6
    s_mul_i32 s47, s3, 35840
    s_add_u32 s47, s47, s75
    v_add_u32_e64 v6, s47, v6
    v_mov_b32 v12, 0x3f803f80
    v_mov_b32 v13, 0x3f803f80
    v_mov_b32 v14, 0x3f803f80
    v_mov_b32 v15, 0x3f803f80
    s_lshl_b32 s47, s3, 9
    s_add_u32 s47, s47, 144640
    v_lshrrev_b32 v7, 4, v1
    v_lshl_add_u32 v7, v7, 4, s47
    s_waitcnt vmcnt(3)
    s_barrier
    ds_read_b64_tr_b16 v[32:33], v6 offset:0
    ds_read_b64_tr_b16 v[34:35], v6 offset:3584
    ds_read_b64_tr_b16 v[36:37], v6 offset:32
    ds_read_b64_tr_b16 v[38:39], v6 offset:3616
    ds_read_b64_tr_b16 v[40:41], v6 offset:64
    ds_read_b64_tr_b16 v[42:43], v6 offset:3648
    ds_read_b64_tr_b16 v[44:45], v6 offset:96
    ds_read_b64_tr_b16 v[46:47], v6 offset:3680
    ds_read_b64_tr_b16 v[48:49], v6 offset:128
    ds_read_b64_tr_b16 v[50:51], v6 offset:3712
    ds_read_b64_tr_b16 v[52:53], v6 offset:160
    ds_read_b64_tr_b16 v[54:55], v6 offset:3744
    ds_read_b64_tr_b16 v[56:57], v6 offset:192
    ds_read_b64_tr_b16 v[58:59], v6 offset:3776
    ds_read_b64_tr_b16 v[60:61], v6 offset:7168
    ds_read_b64_tr_b16 v[62:63], v6 offset:10752
    ds_read_b64_tr_b16 v[64:65], v6 offset:7200
    ds_read_b64_tr_b16 v[66:67], v6 offset:10784
    ds_read_b64_tr_b16 v[68:69], v6 offset:7232
    ds_read_b64_tr_b16 v[70:71], v6 offset:10816
    ds_read_b64_tr_b16 v[72:73], v6 offset:7264
    ds_read_b64_tr_b16 v[74:75], v6 offset:10848
    ds_read_b64_tr_b16 v[76:77], v6 offset:7296
    ds_read_b64_tr_b16 v[78:79], v6 offset:10880
    ds_read_b64_tr_b16 v[80:81], v6 offset:7328
    ds_read_b64_tr_b16 v[82:83], v6 offset:10912
    ds_read_b64_tr_b16 v[84:85], v6 offset:7360
    ds_read_b64_tr_b16 v[86:87], v6 offset:10944
    s_waitcnt lgkmcnt(14)
    s_nop 0
    v_mfma_f32_16x16x32_bf16 v[176:179], v[32:35], v[12:15], 0
    v_mfma_f32_16x16x32_bf16 v[180:183], v[36:39], v[12:15], 0
    v_mfma_f32_16x16x32_bf16 v[184:187], v[40:43], v[12:15], 0
    v_mfma_f32_16x16x32_bf16 v[188:191], v[44:47], v[12:15], 0
    v_mfma_f32_16x16x32_bf16 v[192:195], v[48:51], v[12:15], 0
    v_mfma_f32_16x16x32_bf16 v[196:199], v[52:55], v[12:15], 0
    v_mfma_f32_16x16x32_bf16 v[200:203], v[56:59], v[12:15], 0
    ds_read_b64_tr_b16 v[88:89], v6 offset:14336
    ds_read_b64_tr_b16 v[90:91], v6 offset:17920
    ds_read_b64_tr_b16 v[92:93], v6 offset:14368
    ds_read_b64_tr_b16 v[94:95], v6 offset:17952
    ds_read_b64_tr_b16 v[96:97], v6 offset:14400
    ds_read_b64_tr_b16 v[98:99], v6 offset:17984
    ds_read_b64_tr_b16 v[100:101], v6 offset:14432
    ds_read_b64_tr_b16 v[102:103], v6 offset:18016
    ds_read_b64_tr_b16 v[104:105], v6 offset:14464
    ds_read_b64_tr_b16 v[106:107], v6 offset:18048
    ds_read_b64_tr_b16 v[108:109], v6 offset:14496
    ds_read_b64_tr_b16 v[110:111], v6 offset:18080
    ds_read_b64_tr_b16 v[112:113], v6 offset:14528
    ds_read_b64_tr_b16 v[114:115], v6 offset:18112
    s_waitcnt lgkmcnt(14)
    s_nop 0
    v_mfma_f32_16x16x32_bf16 v[176:179], v[60:63], v[12:15], v[176:179]
    v_mfma_f32_16x16x32_bf16 v[180:183], v[64:67], v[12:15], v[180:183]
    v_mfma_f32_16x16x32_bf16 v[184:187], v[68:71], v[12:15], v[184:187]
    v_mfma_f32_16x16x32_bf16 v[188:191], v[72:75], v[12:15], v[188:191]
    v_mfma_f32_16x16x32_bf16 v[192:195], v[76:79], v[12:15], v[192:195]
    v_mfma_f32_16x16x32_bf16 v[196:199], v[80:83], v[12:15], v[196:199]
    v_mfma_f32_16x16x32_bf16 v[200:203], v[84:87], v[12:15], v[200:203]
    ds_read_b64_tr_b16 v[116:117], v6 offset:21504
    ds_read_b64_tr_b16 v[118:119], v6 offset:25088
    ds_read_b64_tr_b16 v[120:121], v6 offset:21536
    ds_read_b64_tr_b16 v[122:123], v6 offset:25120
    ds_read_b64_tr_b16 v[124:125], v6 offset:21568
    ds_read_b64_tr_b16 v[126:127], v6 offset:25152
    ds_read_b64_tr_b16 v[128:129], v6 offset:21600
    ds_read_b64_tr_b16 v[130:131], v6 offset:25184
    ds_read_b64_tr_b16 v[132:133], v6 offset:21632
    ds_read_b64_tr_b16 v[134:135], v6 offset:25216
    ds_read_b64_tr_b16 v[136:137], v6 offset:21664
    ds_read_b64_tr_b16 v[138:139], v6 offset:25248
    ds_read_b64_tr_b16 v[140:141], v6 offset:21696
    ds_read_b64_tr_b16 v[142:143], v6 offset:25280
    s_waitcnt lgkmcnt(14)
    s_nop 0
    v_mfma_f32_16x16x32_bf16 v[176:179], v[88:91], v[12:15], v[176:179]
    v_mfma_f32_16x16x32_bf16 v[180:183], v[92:95], v[12:15], v[180:183]
    v_mfma_f32_16x16x32_bf16 v[184:187], v[96:99], v[12:15], v[184:187]
    v_mfma_f32_16x16x32_bf16 v[188:191], v[100:103], v[12:15], v[188:191]
    v_mfma_f32_16x16x32_bf16 v[192:195], v[104:107], v[12:15], v[192:195]
    v_mfma_f32_16x16x32_bf16 v[196:199], v[108:111], v[12:15], v[196:199]
    v_mfma_f32_16x16x32_bf16 v[200:203], v[112:115], v[12:15], v[200:203]
    ds_read_b64_tr_b16 v[144:145], v6 offset:28672
    ds_read_b64_tr_b16 v[146:147], v6 offset:32256
    ds_read_b64_tr_b16 v[148:149], v6 offset:28704
    ds_read_b64_tr_b16 v[150:151], v6 offset:32288
    ds_read_b64_tr_b16 v[152:153], v6 offset:28736
    ds_read_b64_tr_b16 v[154:155], v6 offset:32320
    ds_read_b64_tr_b16 v[156:157], v6 offset:28768
    ds_read_b64_tr_b16 v[158:159], v6 offset:32352
    ds_read_b64_tr_b16 v[160:161], v6 offset:28800
    ds_read_b64_tr_b16 v[162:163], v6 offset:32384
    ds_read_b64_tr_b16 v[164:165], v6 offset:28832
    ds_read_b64_tr_b16 v[166:167], v6 offset:32416
    ds_read_b64_tr_b16 v[168:169], v6 offset:28864
    ds_read_b64_tr_b16 v[170:171], v6 offset:32448
    s_waitcnt lgkmcnt(14)
    s_nop 0
    v_mfma_f32_16x16x32_bf16 v[176:179], v[116:119], v[12:15], v[176:179]
    v_mfma_f32_16x16x32_bf16 v[180:183], v[120:123], v[12:15], v[180:183]
    v_mfma_f32_16x16x32_bf16 v[184:187], v[124:127], v[12:15], v[184:187]
    v_mfma_f32_16x16x32_bf16 v[188:191], v[128:131], v[12:15], v[188:191]
    v_mfma_f32_16x16x32_bf16 v[192:195], v[132:135], v[12:15], v[192:195]
    v_mfma_f32_16x16x32_bf16 v[196:199], v[136:139], v[12:15], v[196:199]
    v_mfma_f32_16x16x32_bf16 v[200:203], v[140:143], v[12:15], v[200:203]
    s_waitcnt lgkmcnt(0)
    s_nop 0
    v_mfma_f32_16x16x32_bf16 v[176:179], v[144:147], v[12:15], v[176:179]
    v_mfma_f32_16x16x32_bf16 v[180:183], v[148:151], v[12:15], v[180:183]
    v_mfma_f32_16x16x32_bf16 v[184:187], v[152:155], v[12:15], v[184:187]
    v_mfma_f32_16x16x32_bf16 v[188:191], v[156:159], v[12:15], v[188:191]
    v_mfma_f32_16x16x32_bf16 v[192:195], v[160:163], v[12:15], v[192:195]
    v_mfma_f32_16x16x32_bf16 v[196:199], v[164:167], v[12:15], v[196:199]
    v_mfma_f32_16x16x32_bf16 v[200:203], v[168:171], v[12:15], v[200:203]
    s_mov_b32 exec_lo, 0x00010001
    s_mov_b32 exec_hi, 0x00010001
    ds_write_b128 v7, v[176:179] offset:0
    ds_write_b128 v7, v[180:183] offset:64
    ds_write_b128 v7, v[184:187] offset:128
    ds_write_b128 v7, v[188:191] offset:192
    ds_write_b128 v7, v[192:195] offset:256
    ds_write_b128 v7, v[196:199] offset:320
    ds_write_b128 v7, v[200:203] offset:384
    s_mov_b64 exec, -1
    v_and_b32 v8, 127, v0
    v_lshlrev_b32 v9, 2, v8
    v_add_u32 v9, 144640, v9
    v_lshlrev_b32 v8, 3, v8
    s_and_b32 s6, s2, 7
    s_lshl_b32 s6, s6, 4
    s_add_u32 s6, s6, s2
    s_bfe_u32 s6, s6, 0x40003
    s_lshl_b32 s6, s6, 10
    s_add_u32 s6, s6, 98304
    s_waitcnt lgkmcnt(0)
    s_barrier
    s_nop 0
    ds_read_b32 v16, v9 offset:0
    ds_read_b32 v17, v9 offset:512
    ds_read_b32 v18, v9 offset:1024
    ds_read_b32 v19, v9 offset:1536
    s_waitcnt lgkmcnt(0)
    v_add_f32 v16, v16, v17
    v_add_f32 v18, v18, v19
    v_add_f32 v16, v16, v18
    v_mov_b32 v17, s72
    s_cmp_ge_u32 s3, 2
    s_cbranch_scc1 Lnocs_16
    buffer_store_dwordx2 v[16:17], v8, s[64:67], s6 offen sc1
Lnocs_16:
    v_min_u32 v45, 95, v1
    v_lshlrev_b32 v45, 7, v45
    v_add_u32 v46, 64, v1
    v_min_u32 v46, 95, v46
    v_lshlrev_b32 v46, 7, v46
    s_mov_b32 s62, 16384
    s_mov_b64 s[32:33], -1
    s_mov_b64 s[34:35], -1
Lpoll_17:
    s_mov_b64 exec, s[32:33]
    s_cbranch_execz Lpq_19
    buffer_load_dwordx2 v[208:209], v45, s[64:67], s62 offen sc1
Lpq_19:
    s_mov_b64 exec, s[34:35]
    s_cbranch_execz Lpq_20
    buffer_load_dwordx2 v[210:211], v46, s[64:67], s62 offen sc1
Lpq_20:
    s_mov_b64 exec, -1
    s_waitcnt vmcnt(0)
    v_cmp_ne_u32 s[32:33], s72, v208
    v_cmp_ne_u32 s[34:35], s72, v210
    s_nop 1
    s_or_b64 vcc, s[32:33], s[34:35]
    s_sub_u32 s73, s73, 1
    s_cmp_lt_i32 s73, 0
    s_cbranch_scc1 Lto_21
    s_cbranch_vccnz Lpoll_17
Lto_21:
Lpollx_18:
    s_mov_b32 s22, 0
L_COMMON:
    s_bfe_u32 s58, s2, 0x30004
    v_lshlrev_b32 v5, 4, v1
    s_mov_b32 s4, s22
    s_bfe_u32 s7, s2, 0x30004
    s_mul_i32 s7, s7, 276480
    s_add_u32 s20, s44, s7
    s_addc_u32 s21, s45, 0
    s_add_u32 s20, s20, 0x100000
    s_addc_u32 s21, s21, 0
    s_mov_b32 s22, 0x43800
    s_mov_b32 s23, 0x20000
    s_mul_i32 s46, s3, 5120
    s_add_u32 s49, s46, 0
    s_nop 0
    buffer_load_dwordx4 a[56:59], v5, s[20:23], s49 offen offset:0 sc1
    buffer_load_dwordx4 a[60:63], v5, s[20:23], s49 offen offset:1024 sc1
    buffer_load_dwordx4 a[64:67], v5, s[20:23], s49 offen offset:2048 sc1
    buffer_load_dwordx4 a[68:71], v5, s[20:23], s49 offen offset:3072 sc1
    s_add_u32 s49, s49, 4096
    buffer_load_dwordx4 a[72:75], v5, s[20:23], s49 offen offset:0 sc1
    s_add_u32 s49, s46, 20480
    buffer_load_dwordx4 a[76:79], v5, s[20:23], s49 offen offset:0 sc1
    buffer_load_dwordx4 a[80:83], v5, s[20:23], s49 offen offset:1024 sc1
    buffer_load_dwordx4 a[84:87], v5, s[20:23], s49 offen offset:2048 sc1
    buffer_load_dwordx4 a[88:91], v5, s[20:23], s49 offen offset:3072 sc1
    s_add_u32 s49, s49, 4096
    buffer_load_dwordx4 a[92:95], v5, s[20:23], s49 offen offset:0 sc1
    s_add_u32 s49, s46, 40960
    buffer_load_dwordx4 a[96:99], v5, s[20:23], s49 offen offset:0 sc1
    buffer_load_dwordx4 a[100:103], v5, s[20:23], s49 offen offset:1024 sc1
    buffer_load_dwordx4 a[104:107], v5, s[20:23], s49 offen offset:2048 sc1
    buffer_load_dwordx4 a[108:111], v5, s[20:23], s49 offen offset:3072 sc1
    s_add_u32 s49, s49, 4096
    buffer_load_dwordx4 a[112:115], v5, s[20:23], s49 offen offset:0 sc1
    s_add_u32 s49, s46, 61440
    buffer_load_dwordx4 a[116:119], v5, s[20:23], s49 offen offset:0 sc1
    buffer_load_dwordx4 a[120:123], v5, s[20:23], s49 offen offset:1024 sc1
    buffer_load_dwordx4 a[124:127], v5, s[20:23], s49 offen offset:2048 sc1
    buffer_load_dwordx4 a[128:131], v5, s[20:23], s49 offen offset:3072 sc1
    s_add_u32 s49, s49, 4096
    buffer_load_dwordx4 a[132:135], v5, s[20:23], s49 offen offset:0 sc1
    s_and_b32 s4, s2, 7
    s_lshl_b32 s5, s4, 1
    s_bfe_u32 s6, s2, 0x10007
    s_add_u32 s60, s5, s6
    s_and_b32 s56, s2, 7
    s_lshl_b32 s56, s56, 4
    s_add_u32 s56, s56, s2
    s_bfe_u32 s56, s56, 0x40003
    s_lshl_b32 s57, s60, 2
    s_add_u32 s57, s57, s3
    s_lshl_b32 s5, s60, 1
    s_bfe_u32 s6, s2, 0x10003
    s_add_u32 s59, s5, s6
    v_and_b32 v2, 15, v1
    v_lshrrev_b32 v3, 4, v1
    s_mul_i32 s7, s57, 110592
    s_add_u32 s12, s44, s7
    s_addc_u32 s13, s45, 0
    s_add_u32 s12, s12, 0xa00000
    s_addc_u32 s13, s13, 0
    s_nop 0
    s_mov_b32 s14, 0x1b000
    s_mov_b32 s15, 0x20000
    s_mul_i32 s7, s57, 40960
    s_add_u32 s8, s44, s7
    s_addc_u32 s9, s45, 0
    s_add_u32 s8, s8, 0x700000
    s_addc_u32 s9, s9, 0
    s_mov_b32 s10, 0xa000
    s_mov_b32 s11, 0x20000
    v_lshrrev_b32 v6, 2, v1
    v_mul_u32_u24 v6, 224, v6
    v_and_b32 v7, 3, v1
    v_lshl_add_u32 v6, v7, 3, v6
    v_add_u32 v6, s75, v6
    v_add_u32 v7, 64512, v6
    v_add_u32 v4, 129024, v6
    s_mov_b32 s63, 64
    s_lshl_b32 s47, s3, 9
    s_add_u32 s47, s47, 148480
    v_lshl_add_u32 v8, v3, 4, s47
    v_lshl_add_u32 v9, v1, 3, s47
    v_lshlrev_b32 v10, 2, v2
    v_add_u32 v10, 192, v10
    v_cmp_eq_u32 vcc, 3, v3
    v_mov_b32 v11, 0x40000000
    s_nop 0
    v_cndmask_b32 v11, v5, v11, vcc
    s_lshl_b32 s50, s56, 10
    s_add_u32 s50, s50, 98304
    s_mul_i32 s51, s56, 6912
    s_add_u32 s61, s51, 4096
    s_lshl_b32 s62, s60, 4
    s_add_u32 s62, s62, s56
    s_lshl_b32 s62, s62, 7
    s_add_u32 s62, s62, 65536
    v_min_u32 v24, 159, v1
    v_lshlrev_b32 v24, 7, v24
    v_add_u32 v25, 64, v1
    v_min_u32 v25, 159, v25
    v_lshlrev_b32 v25, 7, v25
    v_add_u32 v26, 128, v1
    v_min_u32 v26, 159, v26
    v_lshlrev_b32 v26, 7, v26
    s_mov_b32 s47, 32768
    s_waitcnt vmcnt(20)
    v_mov_b32 v12, 0x3f80
    v_mov_b32 v13, 0
    s_sub_u32 s6, 8, s75
    v_cmp_gt_u32 vcc, 1048576, v31
    v_add_u32 v14, s6, v31
    s_nop 0
    s_and_saveexec_b64 s[48:49], vcc
    s_nop 0
    ds_write_b64 v14, v[12:13] offset:0
    ds_write_b64 v14, v[12:13] offset:28672
    ds_write_b64 v14, v[12:13] offset:57344
    v_add_u32 v14, 86016, v14
    ds_write_b64 v14, v[12:13] offset:0
    ds_write_b64 v14, v[12:13] offset:28672
    s_mov_b64 exec, s[48:49]
    v_mov_b32 v14, 143360
    ds_write_b64 v14, v[12:13]
    s_cmp_lg_u32 s3, 0
    s_cbranch_scc1 Lph_22
    s_mov_b64 s[32:33], -1
    s_mov_b64 s[34:35], -1
    s_mov_b64 s[36:37], -1
Lpoll_23:
    s_mov_b64 exec, s[32:33]
    s_cbranch_execz Lpq_25
    buffer_load_dwordx2 v[16:17], v24, s[64:67], s47 offen sc1
Lpq_25:
    s_mov_b64 exec, s[34:35]
    s_cbranch_execz Lpq_26
    buffer_load_dwordx2 v[18:19], v25, s[64:67], s47 offen sc1
Lpq_26:
    s_mov_b64 exec, s[36:37]
    s_cbranch_execz Lpq_27
    buffer_load_dwordx2 v[20:21], v26, s[64:67], s47 offen sc1
Lpq_27:
    s_mov_b64 exec, -1
    s_waitcnt vmcnt(0)
    v_cmp_ne_u32 s[32:33], s72, v16
    v_cmp_ne_u32 s[34:35], s72, v18
    v_cmp_ne_u32 s[36:37], s72, v20
    s_nop 0
    s_or_b64 vcc, s[32:33], s[34:35]
    s_or_b64 vcc, vcc, s[36:37]
    s_sub_u32 s73, s73, 1
    s_cmp_lt_i32 s73, 0
    s_cbranch_scc1 Lto_28
    s_cbranch_vccnz Lpoll_23
Lto_28:
Lpollx_24:
Lph_22:
    s_waitcnt lgkmcnt(0)
    s_barrier
L_G1:
    s_mov_b32 s48, 0
    buffer_load_dwordx4 v[96:99], v5, s[8:11], s48 offen offset:0 sc1
    buffer_load_dwordx4 v[100:103], v5, s[8:11], s48 offen offset:1024 sc1
    buffer_load_dwordx4 v[104:107], v5, s[8:11], s48 offen offset:2048 sc1
    buffer_load_dwordx4 v[108:111], v5, s[8:11], s48 offen offset:3072 sc1
    s_mov_b32 s48, 4096
    buffer_load_dwordx4 v[112:115], v5, s[8:11], s48 offen offset:0 sc1
    buffer_load_dwordx4 v[116:119], v5, s[8:11], s48 offen offset:1024 sc1
    buffer_load_dwordx4 v[120:123], v5, s[8:11], s48 offen offset:2048 sc1
    buffer_load_dwordx4 v[124:127], v5, s[8:11], s48 offen offset:3072 sc1
    s_mov_b32 s48, 8192
    buffer_load_dwordx4 v[128:131], v5, s[8:11], s48 offen offset:0 sc1
    buffer_load_dwordx4 v[132:135], v5, s[8:11], s48 offen offset:1024 sc1
    buffer_load_dwordx4 v[136:139], v5, s[8:11], s48 offen offset:2048 sc1
    buffer_load_dwordx4 v[140:143], v5, s[8:11], s48 offen offset:3072 sc1
    ds_read_b64_tr_b16 a[0:1], v6 offset:0
    ds_read_b64_tr_b16 a[2:3], v6 offset:3584
    ds_read_b64_tr_b16 a[4:5], v6 offset:32
    ds_read_b64_tr_b16 a[6:7], v6 offset:3616
    ds_read_b64_tr_b16 a[8:9], v6 offset:64
    ds_read_b64_tr_b16 a[10:11], v6 offset:3648
    ds_read_b64_tr_b16 a[12:13], v6 offset:96
    ds_read_b64_tr_b16 a[14:15], v6 offset:3680
    ds_read_b64_tr_b16 a[16:17], v6 offset:128
    ds_read_b64_tr_b16 a[18:19], v6 offset:3712
    ds_read_b64_tr_b16 a[20:21], v6 offset:160
    ds_read_b64_tr_b16 a[22:23], v6 offset:3744
    ds_read_b64_tr_b16 a[24:25], v6 offset:192
    ds_read_b64_tr_b16 a[26:27], v6 offset:3776
    s_waitcnt vmcnt(10)
    v_swap_b32 v98, v100
    v_swap_b32 v99, v101
    s_waitcnt lgkmcnt(8)
    s_nop 0
    v_mfma_f32_16x16x32_bf16 v[16:19], a[0:3], v[96:99], 0
    ds_read_b64_tr_b16 a[28:29], v6 offset:7168
    s_mov_b32 s48, 12288
    v_mfma_f32_16x16x32_bf16 v[20:23], a[0:3], v[100:103], 0
    ds_read_b64_tr_b16 a[30:31], v6 offset:10752
    buffer_load_dwordx4 v[144:147], v5, s[8:11], s48 offen offset:0 sc1
    v_mfma_f32_16x16x32_bf16 v[24:27], a[4:7], v[96:99], 0
    ds_read_b64_tr_b16 a[32:33], v6 offset:7200
    v_mfma_f32_16x16x32_bf16 v[28:31], a[4:7], v[100:103], 0
    ds_read_b64_tr_b16 a[34:35], v6 offset:10784
    v_mfma_f32_16x16x32_bf16 v[32:35], a[8:11], v[96:99], 0
    ds_read_b64_tr_b16 a[36:37], v6 offset:7232
    buffer_load_dwordx4 v[148:151], v5, s[8:11], s48 offen offset:1024 sc1
    v_mfma_f32_16x16x32_bf16 v[36:39], a[8:11], v[100:103], 0
    ds_read_b64_tr_b16 a[38:39], v6 offset:10816
    s_waitcnt vmcnt(10) lgkmcnt(6)
    v_mfma_f32_16x16x32_bf16 v[40:43], a[12:15], v[96:99], 0
    ds_read_b64_tr_b16 a[40:41], v6 offset:7264
    v_mfma_f32_16x16x32_bf16 v[44:47], a[12:15], v[100:103], 0
    ds_read_b64_tr_b16 a[42:43], v6 offset:10848
    v_swap_b32 v106, v108
    v_mfma_f32_16x16x32_bf16 v[48:51], a[16:19], v[96:99], 0
    ds_read_b64_tr_b16 a[44:45], v6 offset:7296
    v_swap_b32 v107, v109
    v_mfma_f32_16x16x32_bf16 v[52:55], a[16:19], v[100:103], 0
    ds_read_b64_tr_b16 a[46:47], v6 offset:10880
    v_mfma_f32_16x16x32_bf16 v[56:59], a[20:23], v[96:99], 0
    ds_read_b64_tr_b16 a[48:49], v6 offset:7328
    buffer_load_dwordx4 v[152:155], v5, s[8:11], s48 offen offset:2048 sc1
    v_mfma_f32_16x16x32_bf16 v[60:63], a[20:23], v[100:103], 0
    ds_read_b64_tr_b16 a[50:51], v6 offset:10912
    v_mfma_f32_16x16x32_bf16 v[64:67], a[24:27], v[96:99], 0
    ds_read_b64_tr_b16 a[52:53], v6 offset:7360
    v_mfma_f32_16x16x32_bf16 v[68:71], a[24:27], v[100:103], 0
    ds_read_b64_tr_b16 a[54:55], v6 offset:10944
    s_waitcnt lgkmcnt(8)
    v_mfma_f32_16x16x32_bf16 v[16:19], a[28:31], v[104:107], v[16:19]
    ds_read_b64_tr_b16 a[0:1], v6 offset:14336
    v_mfma_f32_16x16x32_bf16 v[20:23], a[28:31], v[108:111], v[20:23]
    ds_read_b64_tr_b16 a[2:3], v6 offset:17920
    buffer_load_dwordx4 v[156:159], v5, s[8:11], s48 offen offset:3072 sc1
    v_mfma_f32_16x16x32_bf16 v[24:27], a[32:35], v[104:107], v[24:27]
    ds_read_b64_tr_b16 a[4:5], v6 offset:14368
    v_mfma_f32_16x16x32_bf16 v[28:31], a[32:35], v[108:111], v[28:31]
    ds_read_b64_tr_b16 a[6:7], v6 offset:17952
    s_mov_b32 s48, 16384
    v_mfma_f32_16x16x32_bf16 v[32:35], a[36:39], v[104:107], v[32:35]
    ds_read_b64_tr_b16 a[8:9], v6 offset:14400
    buffer_load_dwordx4 v[160:163], v5, s[8:11], s48 offen offset:0 sc1
    v_mfma_f32_16x16x32_bf16 v[36:39], a[36:39], v[108:111], v[36:39]
    ds_read_b64_tr_b16 a[10:11], v6 offset:17984
    s_waitcnt vmcnt(11) lgkmcnt(6)
    v_mfma_f32_16x16x32_bf16 v[40:43], a[40:43], v[104:107], v[40:43]
    ds_read_b64_tr_b16 a[12:13], v6 offset:14432
    v_mfma_f32_16x16x32_bf16 v[44:47], a[40:43], v[108:111], v[44:47]
    ds_read_b64_tr_b16 a[14:15], v6 offset:18016
    v_swap_b32 v114, v116
    v_mfma_f32_16x16x32_bf16 v[48:51], a[44:47], v[104:107], v[48:51]
    ds_read_b64_tr_b16 a[16:17], v6 offset:14464
    v_swap_b32 v115, v117
    v_mfma_f32_16x16x32_bf16 v[52:55], a[44:47], v[108:111], v[52:55]
    ds_read_b64_tr_b16 a[18:19], v6 offset:18048
    v_mfma_f32_16x16x32_bf16 v[56:59], a[48:51], v[104:107], v[56:59]
    ds_read_b64_tr_b16 a[20:21], v6 offset:14496
    buffer_load_dwordx4 v[164:167], v5, s[8:11], s48 offen offset:1024 sc1
    v_mfma_f32_16x16x32_bf16 v[60:63], a[48:51], v[108:111], v[60:63]
    ds_read_b64_tr_b16 a[22:23], v6 offset:18080
    v_mfma_f32_16x16x32_bf16 v[64:67], a[52:55], v[104:107], v[64:67]
    ds_read_b64_tr_b16 a[24:25], v6 offset:14528
    v_mfma_f32_16x16x32_bf16 v[68:71], a[52:55], v[108:111], v[68:71]
    ds_read_b64_tr_b16 a[26:27], v6 offset:18112
    s_waitcnt lgkmcnt(8)
    v_mfma_f32_16x16x32_bf16 v[16:19], a[0:3], v[112:115], v[16:19]
    ds_read_b64_tr_b16 a[28:29], v6 offset:21504
    v_mfma_f32_16x16x32_bf16 v[20:23], a[0:3], v[116:119], v[20:23]
    ds_read_b64_tr_b16 a[30:31], v6 offset:25088
    buffer_load_dwordx4 v[168:171], v5, s[8:11], s48 offen offset:2048 sc1
    v_mfma_f32_16x16x32_bf16 v[24:27], a[4:7], v[112:115], v[24:27]
    ds_read_b64_tr_b16 a[32:33], v6 offset:21536
    v_mfma_f32_16x16x32_bf16 v[28:31], a[4:7], v[116:119], v[28:31]
    ds_read_b64_tr_b16 a[34:35], v6 offset:25120
    v_mfma_f32_16x16x32_bf16 v[32:35], a[8:11], v[112:115], v[32:35]
    ds_read_b64_tr_b16 a[36:37], v6 offset:21568
    buffer_load_dwordx4 v[172:175], v5, s[8:11], s48 offen offset:3072 sc1
    v_mfma_f32_16x16x32_bf16 v[36:39], a[8:11], v[116:119], v[36:39]
    ds_read_b64_tr_b16 a[38:39], v6 offset:25152
    s_waitcnt vmcnt(12) lgkmcnt(6)
    v_mfma_f32_16x16x32_bf16 v[40:43], a[12:15], v[112:115], v[40:43]
    ds_read_b64_tr_b16 a[40:41], v6 offset:21600
    v_mfma_f32_16x16x32_bf16 v[44:47], a[12:15], v[116:119], v[44:47]
    ds_read_b64_tr_b16 a[42:43], v6 offset:25184
    v_swap_b32 v122, v124
    v_mfma_f32_16x16x32_bf16 v[48:51], a[16:19], v[112:115], v[48:51]
    ds_read_b64_tr_b16 a[44:45], v6 offset:21632
    v_swap_b32 v123, v125
    v_mfma_f32_16x16x32_bf16 v[52:55], a[16:19], v[116:119], v[52:55]
    ds_read_b64_tr_b16 a[46:47], v6 offset:25216
    s_mov_b32 s48, 20480
    v_mfma_f32_16x16x32_bf16 v[56:59], a[20:23], v[112:115], v[56:59]
    ds_read_b64_tr_b16 a[48:49], v6 offset:21664
    buffer_load_dwordx4 v[176:179], v5, s[8:11], s48 offen offset:0 sc1
    v_mfma_f32_16x16x32_bf16 v[60:63], a[20:23], v[116:119], v[60:63]
    ds_read_b64_tr_b16 a[50:51], v6 offset:25248
    v_mfma_f32_16x16x32_bf16 v[64:67], a[24:27], v[112:115], v[64:67]
    ds_read_b64_tr_b16 a[52:53], v6 offset:21696
    v_mfma_f32_16x16x32_bf16 v[68:71], a[24:27], v[116:119], v[68:71]
    ds_read_b64_tr_b16 a[54:55], v6 offset:25280
    s_waitcnt lgkmcnt(8)
    v_mfma_f32_16x16x32_bf16 v[16:19], a[28:31], v[120:123], v[16:19]
    ds_read_b64_tr_b16 a[0:1], v6 offset:28672
    v_mfma_f32_16x16x32_bf16 v[20:23], a[28:31], v[124:127], v[20:23]
    ds_read_b64_tr_b16 a[2:3], v6 offset:32256
    buffer_load_dwordx4 v[180:183], v5, s[8:11], s48 offen offset:1024 sc1
    v_mfma_f32_16x16x32_bf16 v[24:27], a[32:35], v[120:123], v[24:27]
    ds_read_b64_tr_b16 a[4:5], v6 offset:28704
    v_mfma_f32_16x16x32_bf16 v[28:31], a[32:35], v[124:127], v[28:31]
    ds_read_b64_tr_b16 a[6:7], v6 offset:32288
    v_mfma_f32_16x16x32_bf16 v[32:35], a[36:39], v[120:123], v[32:35]
    ds_read_b64_tr_b16 a[8:9], v6 offset:28736
    buffer_load_dwordx4 v[184:187], v5, s[8:11], s48 offen offset:2048 sc1
    v_mfma_f32_16x16x32_bf16 v[36:39], a[36:39], v[124:127], v[36:39]
    ds_read_b64_tr_b16 a[10:11], v6 offset:32320
    s_waitcnt vmcnt(13) lgkmcnt(6)
    v_mfma_f32_16x16x32_bf16 v[40:43], a[40:43], v[120:123], v[40:43]
    ds_read_b64_tr_b16 a[12:13], v6 offset:28768
    v_mfma_f32_16x16x32_bf16 v[44:47], a[40:43], v[124:127], v[44:47]
    ds_read_b64_tr_b16 a[14:15], v6 offset:32352
    v_swap_b32 v130, v132
    v_mfma_f32_16x16x32_bf16 v[48:51], a[44:47], v[120:123], v[48:51]
    ds_read_b64_tr_b16 a[16:17], v6 offset:28800
    v_swap_b32 v131, v133
    v_mfma_f32_16x16x32_bf16 v[52:55], a[44:47], v[124:127], v[52:55]
    ds_read_b64_tr_b16 a[18:19], v6 offset:32384
    v_mfma_f32_16x16x32_bf16 v[56:59], a[48:51], v[120:123], v[56:59]
    ds_read_b64_tr_b16 a[20:21], v6 offset:28832
    buffer_load_dwordx4 v[188:191], v5, s[8:11], s48 offen offset:3072 sc1
    v_mfma_f32_16x16x32_bf16 v[60:63], a[48:51], v[124:127], v[60:63]
    ds_read_b64_tr_b16 a[22:23], v6 offset:32416
    v_mfma_f32_16x16x32_bf16 v[64:67], a[52:55], v[120:123], v[64:67]
    ds_read_b64_tr_b16 a[24:25], v6 offset:28864
    v_mfma_f32_16x16x32_bf16 v[68:71], a[52:55], v[124:127], v[68:71]
    ds_read_b64_tr_b16 a[26:27], v6 offset:32448
    s_waitcnt lgkmcnt(8)
    v_mfma_f32_16x16x32_bf16 v[16:19], a[0:3], v[128:131], v[16:19]
    ds_read_b64_tr_b16 a[28:29], v6 offset:35840
    s_mov_b32 s48, 24576
    v_mfma_f32_16x16x32_bf16 v[20:23], a[0:3], v[132:135], v[20:23]
    ds_read_b64_tr_b16 a[30:31], v6 offset:39424
    buffer_load_dwordx4 v[192:195], v5, s[8:11], s48 offen offset:0 sc1
    v_mfma_f32_16x16x32_bf16 v[24:27], a[4:7], v[128:131], v[24:27]
    ds_read_b64_tr_b16 a[32:33], v6 offset:35872
    v_mfma_f32_16x16x32_bf16 v[28:31], a[4:7], v[132:135], v[28:31]
    ds_read_b64_tr_b16 a[34:35], v6 offset:39456
    v_mfma_f32_16x16x32_bf16 v[32:35], a[8:11], v[128:131], v[32:35]
    ds_read_b64_tr_b16 a[36:37], v6 offset:35904
    buffer_load_dwordx4 v[196:199], v5, s[8:11], s48 offen offset:1024 sc1
    v_mfma_f32_16x16x32_bf16 v[36:39], a[8:11], v[132:135], v[36:39]
    ds_read_b64_tr_b16 a[38:39], v6 offset:39488
    s_waitcnt vmcnt(14) lgkmcnt(6)
    v_mfma_f32_16x16x32_bf16 v[40:43], a[12:15], v[128:131], v[40:43]
    ds_read_b64_tr_b16 a[40:41], v6 offset:35936
    v_mfma_f32_16x16x32_bf16 v[44:47], a[12:15], v[132:135], v[44:47]
    ds_read_b64_tr_b16 a[42:43], v6 offset:39520
    v_swap_b32 v138, v140
    v_mfma_f32_16x16x32_bf16 v[48:51], a[16:19], v[128:131], v[48:51]
    ds_read_b64_tr_b16 a[44:45], v6 offset:35968
    v_swap_b32 v139, v141
    v_mfma_f32_16x16x32_bf16 v[52:55], a[16:19], v[132:135], v[52:55]
    ds_read_b64_tr_b16 a[46:47], v6 offset:39552
    v_mfma_f32_16x16x32_bf16 v[56:59], a[20:23], v[128:131], v[56:59]
    ds_read_b64_tr_b16 a[48:49], v6 offset:36000
    buffer_load_dwordx4 v[200:203], v5, s[8:11], s48 offen offset:2048 sc1
    v_mfma_f32_16x16x32_bf16 v[60:63], a[20:23], v[132:135], v[60:63]
    ds_read_b64_tr_b16 a[50:51], v6 offset:39584
    v_mfma_f32_16x16x32_bf16 v[64:67], a[24:27], v[128:131], v[64:67]
    ds_read_b64_tr_b16 a[52:53], v6 offset:36032
    v_mfma_f32_16x16x32_bf16 v[68:71], a[24:27], v[132:135], v[68:71]
    ds_read_b64_tr_b16 a[54:55], v6 offset:39616
    s_waitcnt lgkmcnt(8)
    v_mfma_f32_16x16x32_bf16 v[16:19], a[28:31], v[136:139], v[16:19]
    ds_read_b64_tr_b16 a[0:1], v6 offset:43008
    v_mfma_f32_16x16x32_bf16 v[20:23], a[28:31], v[140:143], v[20:23]
    ds_read_b64_tr_b16 a[2:3], v6 offset:46592
    buffer_load_dwordx4 v[204:207], v5, s[8:11], s48 offen offset:3072 sc1
    v_mfma_f32_16x16x32_bf16 v[24:27], a[32:35], v[136:139], v[24:27]
    ds_read_b64_tr_b16 a[4:5], v6 offset:43040
    v_mfma_f32_16x16x32_bf16 v[28:31], a[32:35], v[140:143], v[28:31]
    ds_read_b64_tr_b16 a[6:7], v6 offset:46624
    s_mov_b32 s48, 28672
    v_mfma_f32_16x16x32_bf16 v[32:35], a[36:39], v[136:139], v[32:35]
    ds_read_b64_tr_b16 a[8:9], v6 offset:43072
    buffer_load_dwordx4 v[208:211], v5, s[8:11], s48 offen offset:0 sc1
    v_mfma_f32_16x16x32_bf16 v[36:39], a[36:39], v[140:143], v[36:39]
    ds_read_b64_tr_b16 a[10:11], v6 offset:46656
    s_waitcnt vmcnt(15) lgkmcnt(6)
    v_mfma_f32_16x16x32_bf16 v[40:43], a[40:43], v[136:139], v[40:43]
    ds_read_b64_tr_b16 a[12:13], v6 offset:43104
    v_mfma_f32_16x16x32_bf16 v[44:47], a[40:43], v[140:143], v[44:47]
    ds_read_b64_tr_b16 a[14:15], v6 offset:46688
    v_swap_b32 v146, v148
    v_mfma_f32_16x16x32_bf16 v[48:51], a[44:47], v[136:139], v[48:51]
    ds_read_b64_tr_b16 a[16:17], v6 offset:43136
    v_swap_b32 v147, v149
    v_mfma_f32_16x16x32_bf16 v[52:55], a[44:47], v[140:143], v[52:55]
    ds_read_b64_tr_b16 a[18:19], v6 offset:46720
    v_mfma_f32_16x16x32_bf16 v[56:59], a[48:51], v[136:139], v[56:59]
    ds_read_b64_tr_b16 a[20:21], v6 offset:43168
    buffer_load_dwordx4 v[212:215], v5, s[8:11], s48 offen offset:1024 sc1
    v_mfma_f32_16x16x32_bf16 v[60:63], a[48:51], v[140:143], v[60:63]
    ds_read_b64_tr_b16 a[22:23], v6 offset:46752
    v_mfma_f32_16x16x32_bf16 v[64:67], a[52:55], v[136:139], v[64:67]
    ds_read_b64_tr_b16 a[24:25], v6 offset:43200
    v_mfma_f32_16x16x32_bf16 v[68:71], a[52:55], v[140:143], v[68:71]
    ds_read_b64_tr_b16 a[26:27], v6 offset:46784
    s_waitcnt lgkmcnt(8)
    v_mfma_f32_16x16x32_bf16 v[16:19], a[0:3], v[144:147], v[16:19]
    ds_read_b64_tr_b16 a[28:29], v6 offset:50176
    v_mfma_f32_16x16x32_bf16 v[20:23], a[0:3], v[148:151], v[20:23]
    ds_read_b64_tr_b16 a[30:31], v6 offset:53760
    buffer_load_dwordx4 v[216:219], v5, s[8:11], s48 offen offset:2048 sc1
    v_mfma_f32_16x16x32_bf16 v[24:27], a[4:7], v[144:147], v[24:27]
    ds_read_b64_tr_b16 a[32:33], v6 offset:50208
    v_mfma_f32_16x16x32_bf16 v[28:31], a[4:7], v[148:151], v[28:31]
    ds_read_b64_tr_b16 a[34:35], v6 offset:53792
    v_mfma_f32_16x16x32_bf16 v[32:35], a[8:11], v[144:147], v[32:35]
    ds_read_b64_tr_b16 a[36:37], v6 offset:50240
    buffer_load_dwordx4 v[220:223], v5, s[8:11], s48 offen offset:3072 sc1
    v_mfma_f32_16x16x32_bf16 v[36:39], a[8:11], v[148:151], v[36:39]
    ds_read_b64_tr_b16 a[38:39], v6 offset:53824
    s_waitcnt vmcnt(16) lgkmcnt(6)
    v_mfma_f32_16x16x32_bf16 v[40:43], a[12:15], v[144:147], v[40:43]
    ds_read_b64_tr_b16 a[40:41], v6 offset:50272
    v_mfma_f32_16x16x32_bf16 v[44:47], a[12:15], v[148:151], v[44:47]
    ds_read_b64_tr_b16 a[42:43], v6 offset:53856
    v_swap_b32 v154, v156
    v_mfma_f32_16x16x32_bf16 v[48:51], a[16:19], v[144:147], v[48:51]
    ds_read_b64_tr_b16 a[44:45], v6 offset:50304
    v_swap_b32 v155, v157
    v_mfma_f32_16x16x32_bf16 v[52:55], a[16:19], v[148:151], v[52:55]
    ds_read_b64_tr_b16 a[46:47], v6 offset:53888
    s_mov_b32 s48, 32768
    v_mfma_f32_16x16x32_bf16 v[56:59], a[20:23], v[144:147], v[56:59]
    ds_read_b64_tr_b16 a[48:49], v6 offset:50336
    buffer_load_dwordx4 v[224:227], v5, s[8:11], s48 offen offset:0 sc1
    v_mfma_f32_16x16x32_bf16 v[60:63], a[20:23], v[148:151], v[60:63]
    ds_read_b64_tr_b16 a[50:51], v6 offset:53920
    v_mfma_f32_16x16x32_bf16 v[64:67], a[24:27], v[144:147], v[64:67]
    ds_read_b64_tr_b16 a[52:53], v6 offset:50368
    v_mfma_f32_16x16x32_bf16 v[68:71], a[24:27], v[148:151], v[68:71]
    ds_read_b64_tr_b16 a[54:55], v6 offset:53952
    s_waitcnt lgkmcnt(8)
    v_mfma_f32_16x16x32_bf16 v[16:19], a[28:31], v[152:155], v[16:19]
    ds_read_b64_tr_b16 a[0:1], v6 offset:57344
    v_mfma_f32_16x16x32_bf16 v[20:23], a[28:31], v[156:159], v[20:23]
    ds_read_b64_tr_b16 a[2:3], v6 offset:60928
    buffer_load_dwordx4 v[228:231], v5, s[8:11], s48 offen offset:1024 sc1
    v_mfma_f32_16x16x32_bf16 v[24:27], a[32:35], v[152:155], v[24:27]
    ds_read_b64_tr_b16 a[4:5], v6 offset:57376
    v_mfma_f32_16x16x32_bf16 v[28:31], a[32:35], v[156:159], v[28:31]
    ds_read_b64_tr_b16 a[6:7], v6 offset:60960
    v_mfma_f32_16x16x32_bf16 v[32:35], a[36:39], v[152:155], v[32:35]
    ds_read_b64_tr_b16 a[8:9], v6 offset:57408
    buffer_load_dwordx4 v[232:235], v5, s[8:11], s48 offen offset:2048 sc1
    v_mfma_f32_16x16x32_bf16 v[36:39], a[36:39], v[156:159], v[36:39]
    ds_read_b64_tr_b16 a[10:11], v6 offset:60992
    s_waitcnt vmcnt(17) lgkmcnt(6)
    v_mfma_f32_16x16x32_bf16 v[40:43], a[40:43], v[152:155], v[40:43]
    ds_read_b64_tr_b16 a[12:13], v6 offset:57440
    v_mfma_f32_16x16x32_bf16 v[44:47], a[40:43], v[156:159], v[44:47]
    ds_read_b64_tr_b16 a[14:15], v6 offset:61024
    v_swap_b32 v162, v164
    v_mfma_f32_16x16x32_bf16 v[48:51], a[44:47], v[152:155], v[48:51]
    ds_read_b64_tr_b16 a[16:17], v6 offset:57472
    v_swap_b32 v163, v165
    v_mfma_f32_16x16x32_bf16 v[52:55], a[44:47], v[156:159], v[52:55]
    ds_read_b64_tr_b16 a[18:19], v6 offset:61056
    v_mfma_f32_16x16x32_bf16 v[56:59], a[48:51], v[152:155], v[56:59]
    ds_read_b64_tr_b16 a[20:21], v6 offset:57504
    buffer_load_dwordx4 v[236:239], v5, s[8:11], s48 offen offset:3072 sc1
    v_mfma_f32_16x16x32_bf16 v[60:63], a[48:51], v[156:159], v[60:63]
    ds_read_b64_tr_b16 a[22:23], v6 offset:61088
    v_mfma_f32_16x16x32_bf16 v[64:67], a[52:55], v[152:155], v[64:67]
    ds_read_b64_tr_b16 a[24:25], v6 offset:57536
    v_mfma_f32_16x16x32_bf16 v[68:71], a[52:55], v[156:159], v[68:71]
    ds_read_b64_tr_b16 a[26:27], v6 offset:61120
    s_waitcnt lgkmcnt(8)
    v_mfma_f32_16x16x32_bf16 v[16:19], a[0:3], v[160:163], v[16:19]
    ds_read_b64_tr_b16 a[28:29], v7 offset:0
    s_mov_b32 s48, 36864
    v_mfma_f32_16x16x32_bf16 v[20:23], a[0:3], v[164:167], v[20:23]
    ds_read_b64_tr_b16 a[30:31], v7 offset:3584
    buffer_load_dwordx4 v[240:243], v5, s[8:11], s48 offen offset:0 sc1
    v_mfma_f32_16x16x32_bf16 v[24:27], a[4:7], v[160:163], v[24:27]
    ds_read_b64_tr_b16 a[32:33], v7 offset:32
    v_mfma_f32_16x16x32_bf16 v[28:31], a[4:7], v[164:167], v[28:31]
    ds_read_b64_tr_b16 a[34:35], v7 offset:3616
    v_mfma_f32_16x16x32_bf16 v[32:35], a[8:11], v[160:163], v[32:35]
    ds_read_b64_tr_b16 a[36:37], v7 offset:64
    buffer_load_dwordx4 v[244:247], v5, s[8:11], s48 offen offset:1024 sc1
    v_mfma_f32_16x16x32_bf16 v[36:39], a[8:11], v[164:167], v[36:39]
    ds_read_b64_tr_b16 a[38:39], v7 offset:3648
    s_waitcnt vmcnt(18) lgkmcnt(6)
    v_mfma_f32_16x16x32_bf16 v[40:43], a[12:15], v[160:163], v[40:43]
    ds_read_b64_tr_b16 a[40:41], v7 offset:96
    v_mfma_f32_16x16x32_bf16 v[44:47], a[12:15], v[164:167], v[44:47]
    ds_read_b64_tr_b16 a[42:43], v7 offset:3680
    v_swap_b32 v170, v172
    v_mfma_f32_16x16x32_bf16 v[48:51], a[16:19], v[160:163], v[48:51]
    ds_read_b64_tr_b16 a[44:45], v7 offset:128
    v_swap_b32 v171, v173
    v_mfma_f32_16x16x32_bf16 v[52:55], a[16:19], v[164:167], v[52:55]
    ds_read_b64_tr_b16 a[46:47], v7 offset:3712
    v_mfma_f32_16x16x32_bf16 v[56:59], a[20:23], v[160:163], v[56:59]
    ds_read_b64_tr_b16 a[48:49], v7 offset:160
    buffer_load_dwordx4 v[248:251], v5, s[8:11], s48 offen offset:2048 sc1
    v_mfma_f32_16x16x32_bf16 v[60:63], a[20:23], v[164:167], v[60:63]
    ds_read_b64_tr_b16 a[50:51], v7 offset:3744
    v_mfma_f32_16x16x32_bf16 v[64:67], a[24:27], v[160:163], v[64:67]
    ds_read_b64_tr_b16 a[52:53], v7 offset:192
    v_mfma_f32_16x16x32_bf16 v[68:71], a[24:27], v[164:167], v[68:71]
    ds_read_b64_tr_b16 a[54:55], v7 offset:3776
    s_waitcnt lgkmcnt(8)
    v_mfma_f32_16x16x32_bf16 v[16:19], a[28:31], v[168:171], v[16:19]
    ds_read_b64_tr_b16 a[0:1], v7 offset:7168
    v_mfma_f32_16x16x32_bf16 v[20:23], a[28:31], v[172:175], v[20:23]
    ds_read_b64_tr_b16 a[2:3], v7 offset:10752
    buffer_load_dwordx4 v[252:255], v5, s[8:11], s48 offen offset:3072 sc1
    v_mfma_f32_16x16x32_bf16 v[24:27], a[32:35], v[168:171], v[24:27]
    ds_read_b64_tr_b16 a[4:5], v7 offset:7200
    v_mfma_f32_16x16x32_bf16 v[28:31], a[32:35], v[172:175], v[28:31]
    ds_read_b64_tr_b16 a[6:7], v7 offset:10784
    v_mfma_f32_16x16x32_bf16 v[32:35], a[36:39], v[168:171], v[32:35]
    ds_read_b64_tr_b16 a[8:9], v7 offset:7232
    buffer_load_dwordx4 v[84:87], v5, s[64:67], s50 offen sc1
    v_mfma_f32_16x16x32_bf16 v[36:39], a[36:39], v[172:175], v[36:39]
    ds_read_b64_tr_b16 a[10:11], v7 offset:10816
    s_waitcnt vmcnt(19) lgkmcnt(6)
    v_mfma_f32_16x16x32_bf16 v[40:43], a[40:43], v[168:171], v[40:43]
    ds_read_b64_tr_b16 a[12:13], v7 offset:7264
    v_mfma_f32_16x16x32_bf16 v[44:47], a[40:43], v[172:175], v[44:47]
    ds_read_b64_tr_b16 a[14:15], v7 offset:10848
    v_swap_b32 v178, v180
    v_mfma_f32_16x16x32_bf16 v[48:51], a[44:47], v[168:171], v[48:51]
    ds_read_b64_tr_b16 a[16:17], v7 offset:7296
    v_swap_b32 v179, v181
    v_mfma_f32_16x16x32_bf16 v[52:55], a[44:47], v[172:175], v[52:55]
    ds_read_b64_tr_b16 a[18:19], v7 offset:10880
    s_add_u32 s49, s46, 81920
    v_mfma_f32_16x16x32_bf16 v[56:59], a[48:51], v[168:171], v[56:59]
    ds_read_b64_tr_b16 a[20:21], v7 offset:7328
    buffer_load_dwordx4 a[136:139], v5, s[20:23], s49 offen offset:0 sc1
    v_mfma_f32_16x16x32_bf16 v[60:63], a[48:51], v[172:175], v[60:63]
    ds_read_b64_tr_b16 a[22:23], v7 offset:10912
    v_mfma_f32_16x16x32_bf16 v[64:67], a[52:55], v[168:171], v[64:67]
    ds_read_b64_tr_b16 a[24:25], v7 offset:7360
    v_mfma_f32_16x16x32_bf16 v[68:71], a[52:55], v[172:175], v[68:71]
    ds_read_b64_tr_b16 a[26:27], v7 offset:10944
    s_waitcnt lgkmcnt(8)
    v_mfma_f32_16x16x32_bf16 v[16:19], a[0:3], v[176:179], v[16:19]
    ds_read_b64_tr_b16 a[28:29], v7 offset:14336
    v_mfma_f32_16x16x32_bf16 v[20:23], a[0:3], v[180:183], v[20:23]
    ds_read_b64_tr_b16 a[30:31], v7 offset:17920
    buffer_load_dwordx4 a[140:143], v5, s[20:23], s49 offen offset:1024 sc1
    v_mfma_f32_16x16x32_bf16 v[24:27], a[4:7], v[176:179], v[24:27]
    ds_read_b64_tr_b16 a[32:33], v7 offset:14368
    v_mfma_f32_16x16x32_bf16 v[28:31], a[4:7], v[180:183], v[28:31]
    ds_read_b64_tr_b16 a[34:35], v7 offset:17952
    v_mfma_f32_16x16x32_bf16 v[32:35], a[8:11], v[176:179], v[32:35]
    ds_read_b64_tr_b16 a[36:37], v7 offset:14400
    buffer_load_dwordx4 a[144:147], v5, s[20:23], s49 offen offset:2048 sc1
    v_mfma_f32_16x16x32_bf16 v[36:39], a[8:11], v[180:183], v[36:39]
    ds_read_b64_tr_b16 a[38:39], v7 offset:17984
    s_waitcnt vmcnt(20) lgkmcnt(6)
    v_mfma_f32_16x16x32_bf16 v[40:43], a[12:15], v[176:179], v[40:43]
    ds_read_b64_tr_b16 a[40:41], v7 offset:14432
    v_mfma_f32_16x16x32_bf16 v[44:47], a[12:15], v[180:183], v[44:47]
    ds_read_b64_tr_b16 a[42:43], v7 offset:18016
    v_swap_b32 v186, v188
    v_mfma_f32_16x16x32_bf16 v[48:51], a[16:19], v[176:179], v[48:51]
    ds_read_b64_tr_b16 a[44:45], v7 offset:14464
    v_swap_b32 v187, v189
    v_mfma_f32_16x16x32_bf16 v[52:55], a[16:19], v[180:183], v[52:55]
    ds_read_b64_tr_b16 a[46:47], v7 offset:18048
    v_mfma_f32_16x16x32_bf16 v[56:59], a[20:23], v[176:179], v[56:59]
    ds_read_b64_tr_b16 a[48:49], v7 offset:14496
    buffer_load_dwordx4 a[148:151], v5, s[20:23], s49 offen offset:3072 sc1
    v_mfma_f32_16x16x32_bf16 v[60:63], a[20:23], v[180:183], v[60:63]
    ds_read_b64_tr_b16 a[50:51], v7 offset:18080
    v_mfma_f32_16x16x32_bf16 v[64:67], a[24:27], v[176:179], v[64:67]
    ds_read_b64_tr_b16 a[52:53], v7 offset:14528
    v_mfma_f32_16x16x32_bf16 v[68:71], a[24:27], v[180:183], v[68:71]
    ds_read_b64_tr_b16 a[54:55], v7 offset:18112
    s_waitcnt lgkmcnt(8)
    v_mfma_f32_16x16x32_bf16 v[16:19], a[28:31], v[184:187], v[16:19]
    ds_read_b64_tr_b16 a[0:1], v7 offset:21504
    s_add_u32 s49, s49, 4096
    v_mfma_f32_16x16x32_bf16 v[20:23], a[28:31], v[188:191], v[20:23]
    ds_read_b64_tr_b16 a[2:3], v7 offset:25088
    buffer_load_dwordx4 a[152:155], v5, s[20:23], s49 offen offset:0 sc1
    v_mfma_f32_16x16x32_bf16 v[24:27], a[32:35], v[184:187], v[24:27]
    ds_read_b64_tr_b16 a[4:5], v7 offset:21536
    v_mfma_f32_16x16x32_bf16 v[28:31], a[32:35], v[188:191], v[28:31]
    ds_read_b64_tr_b16 a[6:7], v7 offset:25120
    s_add_u32 s49, s46, 102400
    v_mfma_f32_16x16x32_bf16 v[32:35], a[36:39], v[184:187], v[32:35]
    ds_read_b64_tr_b16 a[8:9], v7 offset:21568
    buffer_load_dwordx4 a[156:159], v5, s[20:23], s49 offen offset:0 sc1
    v_mfma_f32_16x16x32_bf16 v[36:39], a[36:39], v[188:191], v[36:39]
    ds_read_b64_tr_b16 a[10:11], v7 offset:25152
    s_waitcnt vmcnt(21) lgkmcnt(6)
    v_mfma_f32_16x16x32_bf16 v[40:43], a[40:43], v[184:187], v[40:43]
    ds_read_b64_tr_b16 a[12:13], v7 offset:21600
    v_mfma_f32_16x16x32_bf16 v[44:47], a[40:43], v[188:191], v[44:47]
    ds_read_b64_tr_b16 a[14:15], v7 offset:25184
    v_swap_b32 v194, v196
    v_mfma_f32_16x16x32_bf16 v[48:51], a[44:47], v[184:187], v[48:51]
    ds_read_b64_tr_b16 a[16:17], v7 offset:21632
    v_swap_b32 v195, v197
    v_mfma_f32_16x16x32_bf16 v[52:55], a[44:47], v[188:191], v[52:55]
    ds_read_b64_tr_b16 a[18:19], v7 offset:25216
    v_mfma_f32_16x16x32_bf16 v[56:59], a[48:51], v[184:187], v[56:59]
    ds_read_b64_tr_b16 a[20:21], v7 offset:21664
    buffer_load_dwordx4 a[160:163], v5, s[20:23], s49 offen offset:1024 sc1
    v_mfma_f32_16x16x32_bf16 v[60:63], a[48:51], v[188:191], v[60:63]
    ds_read_b64_tr_b16 a[22:23], v7 offset:25248
    v_mfma_f32_16x16x32_bf16 v[64:67], a[52:55], v[184:187], v[64:67]
    ds_read_b64_tr_b16 a[24:25], v7 offset:21696
    v_mfma_f32_16x16x32_bf16 v[68:71], a[52:55], v[188:191], v[68:71]
    ds_read_b64_tr_b16 a[26:27], v7 offset:25280
    s_waitcnt lgkmcnt(8)
    v_mfma_f32_16x16x32_bf16 v[16:19], a[0:3], v[192:195], v[16:19]
    ds_read_b64_tr_b16 a[28:29], v7 offset:28672
    v_mfma_f32_16x16x32_bf16 v[20:23], a[0:3], v[196:199], v[20:23]
    ds_read_b64_tr_b16 a[30:31], v7 offset:32256
    buffer_load_dwordx4 a[164:167], v5, s[20:23], s49 offen offset:2048 sc1
    v_mfma_f32_16x16x32_bf16 v[24:27], a[4:7], v[192:195], v[24:27]
    ds_read_b64_tr_b16 a[32:33], v7 offset:28704
    v_mfma_f32_16x16x32_bf16 v[28:31], a[4:7], v[196:199], v[28:31]
    ds_read_b64_tr_b16 a[34:35], v7 offset:32288
    v_mfma_f32_16x16x32_bf16 v[32:35], a[8:11], v[192:195], v[32:35]
    ds_read_b64_tr_b16 a[36:37], v7 offset:28736
    buffer_load_dwordx4 a[168:171], v5, s[20:23], s49 offen offset:3072 sc1
    v_mfma_f32_16x16x32_bf16 v[36:39], a[8:11], v[196:199], v[36:39]
    ds_read_b64_tr_b16 a[38:39], v7 offset:32320
    s_waitcnt vmcnt(22) lgkmcnt(6)
    v_mfma_f32_16x16x32_bf16 v[40:43], a[12:15], v[192:195], v[40:43]
    ds_read_b64_tr_b16 a[40:41], v7 offset:28768
    v_mfma_f32_16x16x32_bf16 v[44:47], a[12:15], v[196:199], v[44:47]
    ds_read_b64_tr_b16 a[42:43], v7 offset:32352
    v_swap_b32 v202, v204
    v_mfma_f32_16x16x32_bf16 v[48:51], a[16:19], v[192:195], v[48:51]
    ds_read_b64_tr_b16 a[44:45], v7 offset:28800
    v_swap_b32 v203, v205
    v_mfma_f32_16x16x32_bf16 v[52:55], a[16:19], v[196:199], v[52:55]
    ds_read_b64_tr_b16 a[46:47], v7 offset:32384
    s_add_u32 s49, s49, 4096
    v_mfma_f32_16x16x32_bf16 v[56:59], a[20:23], v[192:195], v[56:59]
    ds_read_b64_tr_b16 a[48:49], v7 offset:28832
    buffer_load_dwordx4 a[172:175], v5, s[20:23], s49 offen offset:0 sc1
    v_mfma_f32_16x16x32_bf16 v[60:63], a[20:23], v[196:199], v[60:63]
    ds_read_b64_tr_b16 a[50:51], v7 offset:32416
    v_mfma_f32_16x16x32_bf16 v[64:67], a[24:27], v[192:195], v[64:67]
    ds_read_b64_tr_b16 a[52:53], v7 offset:28864
    v_mfma_f32_16x16x32_bf16 v[68:71], a[24:27], v[196:199], v[68:71]
    ds_read_b64_tr_b16 a[54:55], v7 offset:32448
    s_waitcnt lgkmcnt(8)
    v_mfma_f32_16x16x32_bf16 v[16:19], a[28:31], v[200:203], v[16:19]
    ds_read_b64_tr_b16 a[0:1], v7 offset:35840
    s_add_u32 s49, s46, 122880
    v_mfma_f32_16x16x32_bf16 v[20:23], a[28:31], v[204:207], v[20:23]
    ds_read_b64_tr_b16 a[2:3], v7 offset:39424
    buffer_load_dwordx4 a[176:179], v5, s[20:23], s49 offen offset:0 sc1
    v_mfma_f32_16x16x32_bf16 v[24:27], a[32:35], v[200:203], v[24:27]
    ds_read_b64_tr_b16 a[4:5], v7 offset:35872
    v_mfma_f32_16x16x32_bf16 v[28:31], a[32:35], v[204:207], v[28:31]
    ds_read_b64_tr_b16 a[6:7], v7 offset:39456
    v_mfma_f32_16x16x32_bf16 v[32:35], a[36:39], v[200:203], v[32:35]
    ds_read_b64_tr_b16 a[8:9], v7 offset:35904
    buffer_load_dwordx4 a[180:183], v5, s[20:23], s49 offen offset:1024 sc1
    v_mfma_f32_16x16x32_bf16 v[36:39], a[36:39], v[204:207], v[36:39]
    ds_read_b64_tr_b16 a[10:11], v7 offset:39488
    s_waitcnt vmcnt(23) lgkmcnt(6)
    v_mfma_f32_16x16x32_bf16 v[40:43], a[40:43], v[200:203], v[40:43]
    ds_read_b64_tr_b16 a[12:13], v7 offset:35936
    v_mfma_f32_16x16x32_bf16 v[44:47], a[40:43], v[204:207], v[44:47]
    ds_read_b64_tr_b16 a[14:15], v7 offset:39520
    v_swap_b32 v210, v212
    v_mfma_f32_16x16x32_bf16 v[48:51], a[44:47], v[200:203], v[48:51]
    ds_read_b64_tr_b16 a[16:17], v7 offset:35968
    v_swap_b32 v211, v213
    v_mfma_f32_16x16x32_bf16 v[52:55], a[44:47], v[204:207], v[52:55]
    ds_read_b64_tr_b16 a[18:19], v7 offset:39552
    v_mfma_f32_16x16x32_bf16 v[56:59], a[48:51], v[200:203], v[56:59]
    ds_read_b64_tr_b16 a[20:21], v7 offset:36000
    buffer_load_dwordx4 a[184:187], v5, s[20:23], s49 offen offset:2048 sc1
    v_mfma_f32_16x16x32_bf16 v[60:63], a[48:51], v[204:207], v[60:63]
    ds_read_b64_tr_b16 a[22:23], v7 offset:39584
    v_mfma_f32_16x16x32_bf16 v[64:67], a[52:55], v[200:203], v[64:67]
    ds_read_b64_tr_b16 a[24:25], v7 offset:36032
    v_mfma_f32_16x16x32_bf16 v[68:71], a[52:55], v[204:207], v[68:71]
    ds_read_b64_tr_b16 a[26:27], v7 offset:39616
    s_waitcnt lgkmcnt(8)
    v_mfma_f32_16x16x32_bf16 v[16:19], a[0:3], v[208:211], v[16:19]
    ds_read_b64_tr_b16 a[28:29], v7 offset:43008
    v_mfma_f32_16x16x32_bf16 v[20:23], a[0:3], v[212:215], v[20:23]
    ds_read_b64_tr_b16 a[30:31], v7 offset:46592
    buffer_load_dwordx4 a[188:191], v5, s[20:23], s49 offen offset:3072 sc1
    v_mfma_f32_16x16x32_bf16 v[24:27], a[4:7], v[208:211], v[24:27]
    ds_read_b64_tr_b16 a[32:33], v7 offset:43040
    v_mfma_f32_16x16x32_bf16 v[28:31], a[4:7], v[212:215], v[28:31]
    ds_read_b64_tr_b16 a[34:35], v7 offset:46624
    s_add_u32 s49, s49, 4096
    v_mfma_f32_16x16x32_bf16 v[32:35], a[8:11], v[208:211], v[32:35]
    ds_read_b64_tr_b16 a[36:37], v7 offset:43072
    buffer_load_dwordx4 a[192:195], v5, s[20:23], s49 offen offset:0 sc1
    v_mfma_f32_16x16x32_bf16 v[36:39], a[8:11], v[212:215], v[36:39]
    ds_read_b64_tr_b16 a[38:39], v7 offset:46656
    s_waitcnt vmcnt(24) lgkmcnt(6)
    v_mfma_f32_16x16x32_bf16 v[40:43], a[12:15], v[208:211], v[40:43]
    ds_read_b64_tr_b16 a[40:41], v7 offset:43104
    v_mfma_f32_16x16x32_bf16 v[44:47], a[12:15], v[212:215], v[44:47]
    ds_read_b64_tr_b16 a[42:43], v7 offset:46688
    v_swap_b32 v218, v220
    v_mfma_f32_16x16x32_bf16 v[48:51], a[16:19], v[208:211], v[48:51]
    ds_read_b64_tr_b16 a[44:45], v7 offset:43136
    v_swap_b32 v219, v221
    v_mfma_f32_16x16x32_bf16 v[52:55], a[16:19], v[212:215], v[52:55]
    ds_read_b64_tr_b16 a[46:47], v7 offset:46720
    s_add_u32 s49, s46, 143360
    v_mfma_f32_16x16x32_bf16 v[56:59], a[20:23], v[208:211], v[56:59]
    ds_read_b64_tr_b16 a[48:49], v7 offset:43168
    buffer_load_dwordx4 a[196:199], v5, s[20:23], s49 offen offset:0 sc1
    v_mfma_f32_16x16x32_bf16 v[60:63], a[20:23], v[212:215], v[60:63]
    ds_read_b64_tr_b16 a[50:51], v7 offset:46752
    v_mfma_f32_16x16x32_bf16 v[64:67], a[24:27], v[208:211], v[64:67]
    ds_read_b64_tr_b16 a[52:53], v7 offset:43200
    v_mfma_f32_16x16x32_bf16 v[68:71], a[24:27], v[212:215], v[68:71]
    ds_read_b64_tr_b16 a[54:55], v7 offset:46784
    s_waitcnt vmcnt(16)
    v_xor_b32 v85, s72, v85
    v_xor_b32 v87, s72, v87
    v_or_b32 v85, v85, v87
    v_cmp_ne_u32 vcc, 0, v85
    s_cbranch_vccnz L_CSW
L_CSOK:
    ds_write2_b32 v9, v84, v86 offset0:0 offset1:1
    s_waitcnt lgkmcnt(9)
    v_mfma_f32_16x16x32_bf16 v[16:19], a[28:31], v[216:219], v[16:19]
    ds_read_b64_tr_b16 a[0:1], v7 offset:50176
    v_mfma_f32_16x16x32_bf16 v[20:23], a[28:31], v[220:223], v[20:23]
    ds_read_b64_tr_b16 a[2:3], v7 offset:53760
    buffer_load_dwordx4 a[200:203], v5, s[20:23], s49 offen offset:1024 sc1
    v_mfma_f32_16x16x32_bf16 v[24:27], a[32:35], v[216:219], v[24:27]
    ds_read_b64_tr_b16 a[4:5], v7 offset:50208
    v_mfma_f32_16x16x32_bf16 v[28:31], a[32:35], v[220:223], v[28:31]
    ds_read_b64_tr_b16 a[6:7], v7 offset:53792
    v_mfma_f32_16x16x32_bf16 v[32:35], a[36:39], v[216:219], v[32:35]
    ds_read_b64_tr_b16 a[8:9], v7 offset:50240
    buffer_load_dwordx4 a[204:207], v5, s[20:23], s49 offen offset:2048 sc1
    v_mfma_f32_16x16x32_bf16 v[36:39], a[36:39], v[220:223], v[36:39]
    ds_read_b64_tr_b16 a[10:11], v7 offset:53824
    s_waitcnt vmcnt(25) lgkmcnt(7)
    v_mfma_f32_16x16x32_bf16 v[40:43], a[40:43], v[216:219], v[40:43]
    ds_read_b64_tr_b16 a[12:13], v7 offset:50272
    v_mfma_f32_16x16x32_bf16 v[44:47], a[40:43], v[220:223], v[44:47]
    ds_read_b64_tr_b16 a[14:15], v7 offset:53856
    v_swap_b32 v226, v228
    v_mfma_f32_16x16x32_bf16 v[48:51], a[44:47], v[216:219], v[48:51]
    ds_read_b64_tr_b16 a[16:17], v7 offset:50304
    v_swap_b32 v227, v229
    v_mfma_f32_16x16x32_bf16 v[52:55], a[44:47], v[220:223], v[52:55]
    ds_read_b64_tr_b16 a[18:19], v7 offset:53888
    v_mfma_f32_16x16x32_bf16 v[56:59], a[48:51], v[216:219], v[56:59]
    ds_read_b64_tr_b16 a[20:21], v7 offset:50336
    buffer_load_dwordx4 a[208:211], v5, s[20:23], s49 offen offset:3072 sc1
    v_mfma_f32_16x16x32_bf16 v[60:63], a[48:51], v[220:223], v[60:63]
    ds_read_b64_tr_b16 a[22:23], v7 offset:53920
    v_mfma_f32_16x16x32_bf16 v[64:67], a[52:55], v[216:219], v[64:67]
    ds_read_b64_tr_b16 a[24:25], v7 offset:50368
    v_mfma_f32_16x16x32_bf16 v[68:71], a[52:55], v[220:223], v[68:71]
    ds_read_b64_tr_b16 a[26:27], v7 offset:53952
    s_waitcnt lgkmcnt(8)
    v_mfma_f32_16x16x32_bf16 v[16:19], a[0:3], v[224:227], v[16:19]
    ds_read_b64_tr_b16 a[28:29], v7 offset:57344
    s_add_u32 s49, s49, 4096
    v_mfma_f32_16x16x32_bf16 v[20:23], a[0:3], v[228:231], v[20:23]
    ds_read_b64_tr_b16 a[30:31], v7 offset:60928
    buffer_load_dwordx4 a[212:215], v5, s[20:23], s49 offen offset:0 sc1
    v_mfma_f32_16x16x32_bf16 v[24:27], a[4:7], v[224:227], v[24:27]
    ds_read_b64_tr_b16 a[32:33], v7 offset:57376
    v_mfma_f32_16x16x32_bf16 v[28:31], a[4:7], v[228:231], v[28:31]
    ds_read_b64_tr_b16 a[34:35], v7 offset:60960
    s_add_u32 s49, s46, 163840
    v_mfma_f32_16x16x32_bf16 v[32:35], a[8:11], v[224:227], v[32:35]
    ds_read_b64_tr_b16 a[36:37], v7 offset:57408
    buffer_load_dwordx4 a[216:219], v5, s[20:23], s49 offen offset:0 sc1
    v_mfma_f32_16x16x32_bf16 v[36:39], a[8:11], v[228:231], v[36:39]
    ds_read_b64_tr_b16 a[38:39], v7 offset:60992
    s_waitcnt vmcnt(26) lgkmcnt(6)
    v_mfma_f32_16x16x32_bf16 v[40:43], a[12:15], v[224:227], v[40:43]
    ds_read_b64_tr_b16 a[40:41], v7 offset:57440
    v_mfma_f32_16x16x32_bf16 v[44:47], a[12:15], v[228:231], v[44:47]
    ds_read_b64_tr_b16 a[42:43], v7 offset:61024
    v_swap_b32 v234, v236
    v_mfma_f32_16x16x32_bf16 v[48:51], a[16:19], v[224:227], v[48:51]
    ds_read_b64_tr_b16 a[44:45], v7 offset:57472
    v_swap_b32 v235, v237
    v_mfma_f32_16x16x32_bf16 v[52:55], a[16:19], v[228:231], v[52:55]
    ds_read_b64_tr_b16 a[46:47], v7 offset:61056
    v_mfma_f32_16x16x32_bf16 v[56:59], a[20:23], v[224:227], v[56:59]
    ds_read_b64_tr_b16 a[48:49], v7 offset:57504
    buffer_load_dwordx4 a[220:223], v5, s[20:23], s49 offen offset:1024 sc1
    v_mfma_f32_16x16x32_bf16 v[60:63], a[20:23], v[228:231], v[60:63]
    ds_read_b64_tr_b16 a[50:51], v7 offset:61088
    v_mfma_f32_16x16x32_bf16 v[64:67], a[24:27], v[224:227], v[64:67]
    ds_read_b64_tr_b16 a[52:53], v7 offset:57536
    v_mfma_f32_16x16x32_bf16 v[68:71], a[24:27], v[228:231], v[68:71]
    ds_read_b64_tr_b16 a[54:55], v7 offset:61120
    s_waitcnt lgkmcnt(8)
    v_mfma_f32_16x16x32_bf16 v[16:19], a[28:31], v[232:235], v[16:19]
    ds_read_b64_tr_b16 a[0:1], v4 offset:0
    v_mfma_f32_16x16x32_bf16 v[20:23], a[28:31], v[236:239], v[20:23]
    ds_read_b64_tr_b16 a[2:3], v4 offset:3584
    buffer_load_dwordx4 a[224:227], v5, s[20:23], s49 offen offset:2048 sc1
    v_mfma_f32_16x16x32_bf16 v[24:27], a[32:35], v[232:235], v[24:27]
    ds_read_b64_tr_b16 a[4:5], v4 offset:32
    v_mfma_f32_16x16x32_bf16 v[28:31], a[32:35], v[236:239], v[28:31]
    ds_read_b64_tr_b16 a[6:7], v4 offset:3616
    v_mfma_f32_16x16x32_bf16 v[32:35], a[36:39], v[232:235], v[32:35]
    ds_read_b64_tr_b16 a[8:9], v4 offset:64
    buffer_load_dwordx4 a[228:231], v5, s[20:23], s49 offen offset:3072 sc1
    v_mfma_f32_16x16x32_bf16 v[36:39], a[36:39], v[236:239], v[36:39]
    ds_read_b64_tr_b16 a[10:11], v4 offset:3648
    s_waitcnt vmcnt(27) lgkmcnt(6)
    v_mfma_f32_16x16x32_bf16 v[40:43], a[40:43], v[232:235], v[40:43]
    ds_read_b64_tr_b16 a[12:13], v4 offset:96
    v_mfma_f32_16x16x32_bf16 v[44:47], a[40:43], v[236:239], v[44:47]
    ds_read_b64_tr_b16 a[14:15], v4 offset:3680
    v_swap_b32 v242, v244
    v_mfma_f32_16x16x32_bf16 v[48:51], a[44:47], v[232:235], v[48:51]
    ds_read_b64_tr_b16 a[16:17], v4 offset:128
    v_swap_b32 v243, v245
    v_mfma_f32_16x16x32_bf16 v[52:55], a[44:47], v[236:239], v[52:55]
    ds_read_b64_tr_b16 a[18:19], v4 offset:3712
    s_add_u32 s49, s49, 4096
    v_mfma_f32_16x16x32_bf16 v[56:59], a[48:51], v[232:235], v[56:59]
    ds_read_b64_tr_b16 a[20:21], v4 offset:160
    buffer_load_dwordx4 a[232:235], v5, s[20:23], s49 offen offset:0 sc1
    v_mfma_f32_16x16x32_bf16 v[60:63], a[48:51], v[236:239], v[60:63]
    ds_read_b64_tr_b16 a[22:23], v4 offset:3744
    v_mfma_f32_16x16x32_bf16 v[64:67], a[52:55], v[232:235], v[64:67]
    ds_read_b64_tr_b16 a[24:25], v4 offset:192
    v_mfma_f32_16x16x32_bf16 v[68:71], a[52:55], v[236:239], v[68:71]
    ds_read_b64_tr_b16 a[26:27], v4 offset:3776
    s_waitcnt lgkmcnt(8)
    v_mfma_f32_16x16x32_bf16 v[16:19], a[0:3], v[240:243], v[16:19]
    ds_read_b64_tr_b16 a[52:53], v4 offset:7360
    s_add_u32 s49, s46, 184320
    v_mfma_f32_16x16x32_bf16 v[20:23], a[0:3], v[244:247], v[20:23]
    ds_read_b64_tr_b16 a[54:55], v4 offset:10944
    buffer_load_dwordx4 a[236:239], v5, s[20:23], s49 offen offset:0 sc1
    v_mfma_f32_16x16x32_bf16 v[24:27], a[4:7], v[240:243], v[24:27]
    ds_read_b64_tr_b16 a[28:29], v4 offset:7168
    v_mfma_f32_16x16x32_bf16 v[28:31], a[4:7], v[244:247], v[28:31]
    ds_read_b64_tr_b16 a[30:31], v4 offset:10752
    v_mfma_f32_16x16x32_bf16 v[32:35], a[8:11], v[240:243], v[32:35]
    ds_read_b64_tr_b16 a[32:33], v4 offset:7200
    buffer_load_dwordx4 a[240:243], v5, s[20:23], s49 offen offset:1024 sc1
    v_mfma_f32_16x16x32_bf16 v[36:39], a[8:11], v[244:247], v[36:39]
    ds_read_b64_tr_b16 a[34:35], v4 offset:10784
    s_waitcnt vmcnt(28) lgkmcnt(6)
    v_mfma_f32_16x16x32_bf16 v[40:43], a[12:15], v[240:243], v[40:43]
    ds_read_b64_tr_b16 a[36:37], v4 offset:7232
    v_mfma_f32_16x16x32_bf16 v[44:47], a[12:15], v[244:247], v[44:47]
    ds_read_b64_tr_b16 a[38:39], v4 offset:10816
    v_swap_b32 v250, v252
    v_mfma_f32_16x16x32_bf16 v[48:51], a[16:19], v[240:243], v[48:51]
    ds_read_b64_tr_b16 a[40:41], v4 offset:7264
    v_swap_b32 v251, v253
    v_mfma_f32_16x16x32_bf16 v[52:55], a[16:19], v[244:247], v[52:55]
    ds_read_b64_tr_b16 a[42:43], v4 offset:10848
    v_mfma_f32_16x16x32_bf16 v[56:59], a[20:23], v[240:243], v[56:59]
    ds_read_b64_tr_b16 a[44:45], v4 offset:7296
    buffer_load_dwordx4 a[244:247], v5, s[20:23], s49 offen offset:2048 sc1
    v_mfma_f32_16x16x32_bf16 v[60:63], a[20:23], v[244:247], v[60:63]
    ds_read_b64_tr_b16 a[46:47], v4 offset:10880
    v_mfma_f32_16x16x32_bf16 v[64:67], a[24:27], v[240:243], v[64:67]
    ds_read_b64_tr_b16 a[48:49], v4 offset:7328
    v_mfma_f32_16x16x32_bf16 v[68:71], a[24:27], v[244:247], v[68:71]
    ds_read_b64_tr_b16 a[50:51], v4 offset:10912
    s_waitcnt lgkmcnt(12)
    v_mfma_f32_16x16x32_bf16 v[64:67], a[52:55], v[248:251], v[64:67]
    v_mfma_f32_16x16x32_bf16 v[68:71], a[52:55], v[252:255], v[68:71]
    s_waitcnt lgkmcnt(0)
    v_mfma_f32_16x16x32_bf16 v[16:19], a[28:31], v[248:251], v[16:19]
    ds_read_b128 v[72:75], v8 offset:384
    v_mfma_f32_16x16x32_bf16 v[20:23], a[28:31], v[252:255], v[20:23]
    ds_read_b128 v[76:79], v8 offset:0
    v_mfma_f32_16x16x32_bf16 v[24:27], a[32:35], v[248:251], v[24:27]
    ds_read_b128 v[80:83], v8 offset:64
    v_mfma_f32_16x16x32_bf16 v[28:31], a[32:35], v[252:255], v[28:31]
    ds_bpermute_b32 v12, v10, v64
    v_mfma_f32_16x16x32_bf16 v[32:35], a[36:39], v[248:251], v[32:35]
    ds_bpermute_b32 v13, v10, v68
    v_mfma_f32_16x16x32_bf16 v[36:39], a[36:39], v[252:255], v[36:39]
    ds_read_b128 v[84:87], v8 offset:128
    v_mfma_f32_16x16x32_bf16 v[40:43], a[40:43], v[248:251], v[40:43]
    ds_read_b128 v[88:91], v8 offset:192
    v_mfma_f32_16x16x32_bf16 v[44:47], a[40:43], v[252:255], v[44:47]
    v_mfma_f32_16x16x32_bf16 v[48:51], a[44:47], v[248:251], v[48:51]
    v_mfma_f32_16x16x32_bf16 v[52:55], a[44:47], v[252:255], v[52:55]
    s_waitcnt lgkmcnt(2)
    v_cmp_u_f32 vcc, v12, v13
    v_mul_f32 v12, 0x3acccccd, v12
    v_mfma_f32_16x16x32_bf16 v[56:59], a[48:51], v[248:251], v[56:59]
    v_mul_f32 v13, 0x3acccccd, v13
    v_cvt_pk_bf16_f32 v94, -v12, -v13
    v_mfma_f32_16x16x32_bf16 v[60:63], a[48:51], v[252:255], v[60:63]
    v_lshlrev_b32 v92, 16, v94
    v_and_b32 v94, 0xffff0000, v94
    s_cbranch_vccnz L_G1RETRY
L_G1OK:
    v_pk_fma_f32 v[64:65], v[72:73], v[92:93], v[64:65] op_sel_hi:[1,0,1]
    v_pk_fma_f32 v[66:67], v[74:75], v[92:93], v[66:67] op_sel_hi:[1,0,1]
    v_pk_fma_f32 v[68:69], v[72:73], v[94:95], v[68:69] op_sel_hi:[1,0,1]
    v_pk_fma_f32 v[70:71], v[74:75], v[94:95], v[70:71] op_sel_hi:[1,0,1]
    ds_read_b128 v[72:75], v8 offset:256
    v_cvt_pk_bf16_f32 v64, v64, v65
    v_cvt_pk_bf16_f32 v65, v66, v67
    v_cvt_pk_bf16_f32 v66, v68, v69
    v_cvt_pk_bf16_f32 v67, v70, v71
    v_pk_max_i16 v64, v64, 0
    v_pk_max_i16 v65, v65, 0
    v_pk_max_i16 v66, v66, 0
    v_pk_max_i16 v67, v67, 0
    buffer_store_dwordx4 v[64:67], v11, s[12:15], s61 offen offset:2048 sc1
    v_pk_fma_f32 v[16:17], v[76:77], v[92:93], v[16:17] op_sel_hi:[1,0,1]
    v_pk_fma_f32 v[18:19], v[78:79], v[92:93], v[18:19] op_sel_hi:[1,0,1]
    v_pk_fma_f32 v[20:21], v[76:77], v[94:95], v[20:21] op_sel_hi:[1,0,1]
    v_pk_fma_f32 v[22:23], v[78:79], v[94:95], v[22:23] op_sel_hi:[1,0,1]
    ds_read_b128 v[76:79], v8 offset:320
    v_cvt_pk_bf16_f32 v16, v16, v17
    v_cvt_pk_bf16_f32 v17, v18, v19
    v_cvt_pk_bf16_f32 v18, v20, v21
    v_cvt_pk_bf16_f32 v19, v22, v23
    v_pk_max_i16 v16, v16, 0
    v_pk_max_i16 v17, v17, 0
    v_pk_max_i16 v18, v18, 0
    v_pk_max_i16 v19, v19, 0
    buffer_store_dwordx4 v[16:19], v5, s[12:15], s51 offen offset:0 sc1
    v_pk_fma_f32 v[24:25], v[80:81], v[92:93], v[24:25] op_sel_hi:[1,0,1]
    v_pk_fma_f32 v[26:27], v[82:83], v[92:93], v[26:27] op_sel_hi:[1,0,1]
    v_pk_fma_f32 v[28:29], v[80:81], v[94:95], v[28:29] op_sel_hi:[1,0,1]
    v_pk_fma_f32 v[30:31], v[82:83], v[94:95], v[30:31] op_sel_hi:[1,0,1]
    v_cvt_pk_bf16_f32 v24, v24, v25
    v_cvt_pk_bf16_f32 v25, v26, v27
    v_cvt_pk_bf16_f32 v26, v28, v29
    v_cvt_pk_bf16_f32 v27, v30, v31
    v_pk_max_i16 v24, v24, 0
    v_pk_max_i16 v25, v25, 0
    v_pk_max_i16 v26, v26, 0
    v_pk_max_i16 v27, v27, 0
    buffer_store_dwordx4 v[24:27], v5, s[12:15], s51 offen offset:1024 sc1
    s_waitcnt lgkmcnt(3)
    s_nop 0
    v_pk_fma_f32 v[32:33], v[84:85], v[92:93], v[32:33] op_sel_hi:[1,0,1]
    v_pk_fma_f32 v[34:35], v[86:87], v[92:93], v[34:35] op_sel_hi:[1,0,1]
    v_pk_fma_f32 v[36:37], v[84:85], v[94:95], v[36:37] op_sel_hi:[1,0,1]
    v_pk_fma_f32 v[38:39], v[86:87], v[94:95], v[38:39] op_sel_hi:[1,0,1]
    v_cvt_pk_bf16_f32 v32, v32, v33
    v_cvt_pk_bf16_f32 v33, v34, v35
    v_cvt_pk_bf16_f32 v34, v36, v37
    v_cvt_pk_bf16_f32 v35, v38, v39
    v_pk_max_i16 v32, v32, 0
    v_pk_max_i16 v33, v33, 0
    v_pk_max_i16 v34, v34, 0
    v_pk_max_i16 v35, v35, 0
    buffer_store_dwordx4 v[32:35], v5, s[12:15], s51 offen offset:2048 sc1
    s_waitcnt lgkmcnt(2)
    s_nop 0
    v_pk_fma_f32 v[40:41], v[88:89], v[92:93], v[40:41] op_sel_hi:[1,0,1]
    v_pk_fma_f32 v[42:43], v[90:91], v[92:93], v[42:43] op_sel_hi:[1,0,1]
    v_pk_fma_f32 v[44:45], v[88:89], v[94:95], v[44:45] op_sel_hi:[1,0,1]
    v_pk_fma_f32 v[46:47], v[90:91], v[94:95], v[46:47] op_sel_hi:[1,0,1]
    v_cvt_pk_bf16_f32 v40, v40, v41
    v_cvt_pk_bf16_f32 v41, v42, v43
    v_cvt_pk_bf16_f32 v42, v44, v45
    v_cvt_pk_bf16_f32 v43, v46, v47
    v_pk_max_i16 v40, v40, 0
    v_pk_max_i16 v41, v41, 0
    v_pk_max_i16 v42, v42, 0
    v_pk_max_i16 v43, v43, 0
    buffer_store_dwordx4 v[40:43], v5, s[12:15], s51 offen offset:3072 sc1
    s_waitcnt lgkmcnt(1)
    s_nop 0
    v_pk_fma_f32 v[48:49], v[72:73], v[92:93], v[48:49] op_sel_hi:[1,0,1]
    v_pk_fma_f32 v[50:51], v[74:75], v[92:93], v[50:51] op_sel_hi:[1,0,1]
    v_pk_fma_f32 v[52:53], v[72:73], v[94:95], v[52:53] op_sel_hi:[1,0,1]
    v_pk_fma_f32 v[54:55], v[74:75], v[94:95], v[54:55] op_sel_hi:[1,0,1]
    v_cvt_pk_bf16_f32 v48, v48, v49
    v_cvt_pk_bf16_f32 v49, v50, v51
    v_cvt_pk_bf16_f32 v50, v52, v53
    v_cvt_pk_bf16_f32 v51, v54, v55
    v_pk_max_i16 v48, v48, 0
    v_pk_max_i16 v49, v49, 0
    v_pk_max_i16 v50, v50, 0
    v_pk_max_i16 v51, v51, 0
    buffer_store_dwordx4 v[48:51], v5, s[12:15], s61 offen offset:0 sc1
    s_waitcnt lgkmcnt(0)
    s_nop 0
    v_pk_fma_f32 v[56:57], v[76:77], v[92:93], v[56:57] op_sel_hi:[1,0,1]
    v_pk_fma_f32 v[58:59], v[78:79], v[92:93], v[58:59] op_sel_hi:[1,0,1]
    v_pk_fma_f32 v[60:61], v[76:77], v[94:95], v[60:61] op_sel_hi:[1,0,1]
    v_pk_fma_f32 v[62:63], v[78:79], v[94:95], v[62:63] op_sel_hi:[1,0,1]
    v_cvt_pk_bf16_f32 v56, v56, v57
    v_cvt_pk_bf16_f32 v57, v58, v59
    v_cvt_pk_bf16_f32 v58, v60, v61
    v_cvt_pk_bf16_f32 v59, v62, v63
    v_pk_max_i16 v56, v56, 0
    v_pk_max_i16 v57, v57, 0
    v_pk_max_i16 v58, v58, 0
    v_pk_max_i16 v59, v59, 0
    buffer_store_dwordx4 v[56:59], v5, s[12:15], s61 offen offset:1024 sc1
    v_mfma_f32_16x16x32_bf16 v[72:75], v[192:195], v[192:195], 0
    v_mfma_f32_16x16x32_bf16 v[76:79], v[196:199], v[196:199], 0
    v_mfma_f32_16x16x32_bf16 v[72:75], v[200:203], v[200:203], v[72:75]
    v_mfma_f32_16x16x32_bf16 v[76:79], v[204:207], v[204:207], v[76:79]
    buffer_load_dwordx4 a[248:251], v5, s[20:23], s49 offen offset:3072 sc1
    v_mfma_f32_16x16x32_bf16 v[72:75], v[208:211], v[208:211], v[72:75]
    v_mfma_f32_16x16x32_bf16 v[76:79], v[212:215], v[212:215], v[76:79]
    v_mfma_f32_16x16x32_bf16 v[72:75], v[216:219], v[216:219], v[72:75]
    v_mfma_f32_16x16x32_bf16 v[76:79], v[220:223], v[220:223], v[76:79]
    s_add_u32 s49, s49, 4096
    buffer_load_dwordx4 a[252:255], v5, s[20:23], s49 offen offset:0 sc1
    v_mfma_f32_16x16x32_bf16 v[72:75], v[224:227], v[224:227], v[72:75]
    v_mfma_f32_16x16x32_bf16 v[76:79], v[228:231], v[228:231], v[76:79]
    v_mfma_f32_16x16x32_bf16 v[72:75], v[232:235], v[232:235], v[72:75]
    v_mfma_f32_16x16x32_bf16 v[76:79], v[236:239], v[236:239], v[76:79]
    s_add_u32 s49, s46, 204800
    buffer_load_dwordx4 a[0:3], v5, s[20:23], s49 offen offset:0 sc1
    v_mfma_f32_16x16x32_bf16 v[72:75], v[240:243], v[240:243], v[72:75]
    v_mfma_f32_16x16x32_bf16 v[76:79], v[244:247], v[244:247], v[76:79]
    v_mfma_f32_16x16x32_bf16 v[72:75], v[248:251], v[248:251], v[72:75]
    v_mfma_f32_16x16x32_bf16 v[76:79], v[252:255], v[252:255], v[76:79]
    buffer_load_dwordx4 a[4:7], v5, s[20:23], s49 offen offset:1024 sc1
    v_mfma_f32_16x16x32_bf16 v[72:75], v[96:99], v[96:99], v[72:75]
    v_mfma_f32_16x16x32_bf16 v[76:79], v[100:103], v[100:103], v[76:79]
    v_mfma_f32_16x16x32_bf16 v[72:75], v[104:107], v[104:107], v[72:75]
    v_mfma_f32_16x16x32_bf16 v[76:79], v[108:111], v[108:111], v[76:79]
    buffer_load_dwordx4 a[8:11], v5, s[20:23], s49 offen offset:2048 sc1
    v_mfma_f32_16x16x32_bf16 v[72:75], v[112:115], v[112:115], v[72:75]
    v_mfma_f32_16x16x32_bf16 v[76:79], v[116:119], v[116:119], v[76:79]
    v_mfma_f32_16x16x32_bf16 v[72:75], v[120:123], v[120:123], v[72:75]
    v_mfma_f32_16x16x32_bf16 v[76:79], v[124:127], v[124:127], v[76:79]
    buffer_load_dwordx4 a[12:15], v5, s[20:23], s49 offen offset:3072 sc1
    v_mfma_f32_16x16x32_bf16 v[72:75], v[128:131], v[128:131], v[72:75]
    v_mfma_f32_16x16x32_bf16 v[76:79], v[132:135], v[132:135], v[76:79]
    v_mfma_f32_16x16x32_bf16 v[72:75], v[136:139], v[136:139], v[72:75]
    v_mfma_f32_16x16x32_bf16 v[76:79], v[140:143], v[140:143], v[76:79]
    s_add_u32 s49, s49, 4096
    buffer_load_dwordx4 a[16:19], v5, s[20:23], s49 offen offset:0 sc1
    v_mfma_f32_16x16x32_bf16 v[72:75], v[144:147], v[144:147], v[72:75]
    v_mfma_f32_16x16x32_bf16 v[76:79], v[148:151], v[148:151], v[76:79]
    v_mfma_f32_16x16x32_bf16 v[72:75], v[152:155], v[152:155], v[72:75]
    v_mfma_f32_16x16x32_bf16 v[76:79], v[156:159], v[156:159], v[76:79]
    s_add_u32 s49, s46, 225280
    buffer_load_dwordx4 a[20:23], v5, s[20:23], s49 offen offset:0 sc1
    v_mfma_f32_16x16x32_bf16 v[72:75], v[160:163], v[160:163], v[72:75]
    v_mfma_f32_16x16x32_bf16 v[76:79], v[164:167], v[164:167], v[76:79]
    v_mfma_f32_16x16x32_bf16 v[72:75], v[168:171], v[168:171], v[72:75]
    v_mfma_f32_16x16x32_bf16 v[76:79], v[172:175], v[172:175], v[76:79]
    buffer_load_dwordx4 a[24:27], v5, s[20:23], s49 offen offset:1024 sc1
    v_mfma_f32_16x16x32_bf16 v[72:75], v[176:179], v[176:179], v[72:75]
    v_mfma_f32_16x16x32_bf16 v[76:79], v[180:183], v[180:183], v[76:79]
    v_mfma_f32_16x16x32_bf16 v[72:75], v[184:187], v[184:187], v[72:75]
    v_mfma_f32_16x16x32_bf16 v[76:79], v[188:191], v[188:191], v[76:79]
    buffer_load_dwordx4 a[28:31], v5, s[20:23], s49 offen offset:2048 sc1
    s_lshl_b32 s4, s59, 1
    s_lshr_b32 s6, s3, 1
    s_add_u32 s5, s6, s4
    s_mul_i32 s7, s5, 40960
    s_add_u32 s8, s44, s7
    s_addc_u32 s9, s45, 0
    s_add_u32 s8, s8, 0x700000
    s_addc_u32 s9, s9, 0
    s_mov_b32 s10, 0xa000
    s_mov_b32 s11, 0x20000
    s_mul_i32 s18, s58, 5120
    s_and_b32 s5, s3, 1
    s_lshl_b32 s5, s5, 3
    s_add_u32 s18, s18, s5
    s_add_u32 s19, s18, 4096
    v_and_b32 v8, 3, v2
    v_cmp_eq_u32 vcc, 1, v8
    s_nop 1
    v_cndmask_b32 v72, v72, v73, vcc
    v_cndmask_b32 v76, v76, v77, vcc
    v_cmp_eq_u32 vcc, 2, v8
    s_nop 1
    v_cndmask_b32 v72, v72, v74, vcc
    v_cndmask_b32 v76, v76, v78, vcc
    v_cmp_eq_u32 vcc, 3, v8
    s_nop 1
    v_cndmask_b32 v72, v72, v75, vcc
    v_cndmask_b32 v76, v76, v79, vcc
    v_mul_f32 v72, 0x3acccccd, v72
    v_mul_f32 v76, 0x3acccccd, v76
    v_fma_f32 v72, -v12, v12, v72
    v_fma_f32 v76, -v13, v13, v76
    v_max_f32 v72, 0, v72
    v_max_f32 v76, 0, v76
    v_cvt_pk_bf16_f32 v9, v72, v76
    v_lshlrev_b32_e64 v72, 16, v9
    v_and_b32 v76, 0xffff0000, v9
    v_add_f32 v72, 0x3727c5ac, v72
    v_add_f32 v76, 0x3727c5ac, v76
    v_cvt_pk_bf16_f32 v9, v72, v76
    v_lshlrev_b32 v72, 16, v9
    v_and_b32 v76, 0xffff0000, v9
    v_sqrt_f32 v72, v72
    v_sqrt_f32 v76, v76
    s_nop 0
    v_cvt_pk_bf16_f32 v9, v72, v76
    v_lshlrev_b32 v72, 16, v9
    v_and_b32 v76, 0xffff0000, v9
    v_rcp_f32 v72, v72
    v_rcp_f32 v76, v76
    v_lshrrev_b32 v8, 2, v2
    s_lshl_b32 s6, s3, 7
    s_add_u32 s6, s6, 151552
    v_lshl_add_u32 v9, v2, 2, s6
    v_cmp_eq_u32 vcc, v8, v3
    s_nop 1
    s_and_saveexec_b64 s[32:33], vcc
    ds_write2_b32 v9, v72, v76 offset0:0 offset1:16
    s_mov_b64 exec, s[32:33]
    s_lshl_b32 s4, s59, 1
    s_lshr_b32 s6, s3, 1
    s_xor_b32 s5, s6, 0
    s_add_u32 s5, s5, s4
    s_mul_i32 s7, s5, 110592
    s_add_u32 s24, s44, s7
    s_addc_u32 s25, s45, 0
    s_add_u32 s24, s24, 0xa00000
    s_addc_u32 s25, s25, 0
    s_mov_b32 s26, 0x1b000
    s_mov_b32 s27, 0x20000
    s_xor_b32 s5, s6, 1
    s_add_u32 s5, s5, s4
    s_mul_i32 s7, s5, 110592
    s_add_u32 s28, s44, s7
    s_addc_u32 s29, s45, 0
    s_add_u32 s28, s28, 0xa00000
    s_addc_u32 s29, s29, 0
    s_mov_b32 s30, 0x1b000
    s_mov_b32 s31, 0x20000
    v_lshlrev_b32 v8, 7, v2
    s_lshl_b32 s47, s60, 11
    s_add_u32 s47, s47, 65536
    s_add_u32 s61, s62, 65536
    s_mov_b32 s63, 24
    v_mov_b32 v14, s72
    v_mov_b32 v15, 0
    s_waitcnt vmcnt(10)
    s_barrier
    s_cmp_lg_u32 s3, 0
    s_cbranch_scc1 Lfa_29
    s_mov_b64 exec, 1
    buffer_store_dword v14, v15, s[64:67], s62 offen
    s_mov_b64 exec, -1
Lfa_29:
    buffer_load_dwordx4 a[32:35], v5, s[20:23], s49 offen offset:3072 sc1
    s_add_u32 s49, s49, 4096
    buffer_load_dwordx4 a[36:39], v5, s[20:23], s49 offen offset:0 sc1
    s_add_u32 s49, s46, 245760
    buffer_load_dwordx4 v[192:195], v5, s[20:23], s49 offen offset:0 sc1
    buffer_load_dwordx4 v[196:199], v5, s[20:23], s49 offen offset:1024 sc1
    buffer_load_dwordx4 v[200:203], v5, s[20:23], s49 offen offset:2048 sc1
    buffer_load_dwordx4 v[204:207], v5, s[20:23], s49 offen offset:3072 sc1
    s_cmp_lg_u32 s3, 0
    s_cbranch_scc1 Lp1_30
Lp1l_31:
    buffer_load_dword v12, v8, s[64:67], s47 offen sc1
    s_waitcnt vmcnt(0)
    v_cmp_ne_u32 vcc, s72, v12
    s_cbranch_vccz Lp1_30
    s_sub_u32 s63, s63, 1
    s_cbranch_scc0 Lp1l_31
    s_branch L_SLOW1
Lp1_30:
L_SLOW1X:
    s_lshl_b32 s47, s3, 11
    s_waitcnt lgkmcnt(0)
    s_barrier
    s_add_u32 s48, s47, 0
    buffer_load_dwordx4 v[96:99], v5, s[28:31], s48 offen offset:0 sc1
    buffer_load_dwordx4 v[100:103], v5, s[28:31], s48 offen offset:1024 sc1
    s_add_u32 s48, s47, 8192
    buffer_load_dwordx4 v[104:107], v5, s[28:31], s48 offen offset:0 sc1
    buffer_load_dwordx4 v[108:111], v5, s[28:31], s48 offen offset:1024 sc1
    s_add_u32 s48, s47, 16384
    buffer_load_dwordx4 v[112:115], v5, s[28:31], s48 offen offset:0 sc1
    buffer_load_dwordx4 v[116:119], v5, s[28:31], s48 offen offset:1024 sc1
    s_add_u32 s48, s47, 24576
    buffer_load_dwordx4 v[120:123], v5, s[28:31], s48 offen offset:0 sc1
    buffer_load_dwordx4 v[124:127], v5, s[28:31], s48 offen offset:1024 sc1
    s_add_u32 s48, s47, 32768
    buffer_load_dwordx4 v[128:131], v5, s[28:31], s48 offen offset:0 sc1
    buffer_load_dwordx4 v[132:135], v5, s[28:31], s48 offen offset:1024 sc1
    s_add_u32 s48, s47, 40960
    buffer_load_dwordx4 v[136:139], v5, s[28:31], s48 offen offset:0 sc1
    buffer_load_dwordx4 v[140:143], v5, s[28:31], s48 offen offset:1024 sc1
    s_bfe_u32 s6, s2, 0x10003
    s_lshl_b32 s6, s6, 2
    s_add_u32 s6, s6, s3
    s_lshl_b32 s6, s6, 6
    s_nop 0
    s_add_u32 s6, s6, 151552
    v_lshl_add_u32 v4, v2, 2, s6
    ds_read_b32 v12, v4
    s_xor_b32 s6, s3, 1
    s_mul_i32 s6, s6, 20480
    s_add_u32 s6, s6, 5120
    v_add_u32 v6, s6, v5
    s_and_b32 s5, s3, 2
    s_xor_b32 s5, s5, 2
    s_xor_b32 s6, s5, s3
    s_mul_i32 s5, s5, 20480
    s_mul_i32 s6, s6, 5120
    s_add_u32 s6, s6, s5
    v_add_u32 v7, s6, v5
    s_and_b32 s5, s3, 2
    s_xor_b32 s5, s5, 3
    s_xor_b32 s6, s5, s3
    s_mul_i32 s5, s5, 20480
    s_mul_i32 s6, s6, 5120
    s_add_u32 s6, s6, s5
    v_add_u32 v8, s6, v5
    s_mul_i32 s6, s3, 20480
    v_add_u32 v9, s6, v5
    s_mov_b32 s12, s40
    s_mov_b32 s13, s41
    s_nop 0
    s_mov_b32 s14, 0x280000
    s_mov_b32 s15, 0x20000
    v_mul_u32_u24 v10, 1280, v2
    v_and_b32 v11, 1, v3
    v_lshl_add_u32 v11, v11, 5, v10
    v_lshrrev_b32 v13, 1, v3
    v_lshl_add_u32 v11, v13, 4, v11
    v_lshl_add_u32 v10, v3, 3, v10
    s_lshl_b32 s50, s59, 2
    s_add_u32 s50, s50, s3
    s_mul_i32 s50, s50, 20480
    s_mul_i32 s51, s58, 160
    s_add_u32 s50, s50, s51
    s_waitcnt vmcnt(10)
    v_swap_b32 v98, v100
    v_swap_b32 v99, v101
    s_nop 1
    v_mfma_f32_16x16x32_bf16 v[56:59], a[56:59], v[96:99], 0
    s_add_u32 s48, s47, 49152
    buffer_load_dwordx4 v[144:147], v5, s[28:31], s48 offen offset:0 sc1
    v_mfma_f32_16x16x32_bf16 v[76:79], a[56:59], v[100:103], 0
    v_mfma_f32_16x16x32_bf16 v[60:63], a[60:63], v[96:99], 0
    v_mfma_f32_16x16x32_bf16 v[80:83], a[60:63], v[100:103], 0
    buffer_load_dwordx4 v[148:151], v5, s[28:31], s48 offen offset:1024 sc1
    v_mfma_f32_16x16x32_bf16 v[64:67], a[64:67], v[96:99], 0
    s_waitcnt vmcnt(10)
    v_mfma_f32_16x16x32_bf16 v[84:87], a[64:67], v[100:103], 0
    v_swap_b32 v106, v108
    v_mfma_f32_16x16x32_bf16 v[68:71], a[68:71], v[96:99], 0
    v_swap_b32 v107, v109
    v_mfma_f32_16x16x32_bf16 v[88:91], a[68:71], v[100:103], 0
    v_mfma_f32_16x16x32_bf16 v[72:75], a[72:75], v[96:99], 0
    s_add_u32 s49, s49, 4096
    buffer_load_dwordx4 v[208:211], v5, s[20:23], s49 offen offset:0 sc1
    v_mfma_f32_16x16x32_bf16 v[92:95], a[72:75], v[100:103], 0
    v_mfma_f32_16x16x32_bf16 v[56:59], a[76:79], v[104:107], v[56:59]
    s_add_u32 s48, s47, 57344
    buffer_load_dwordx4 v[152:155], v5, s[28:31], s48 offen offset:0 sc1
    v_mfma_f32_16x16x32_bf16 v[76:79], a[76:79], v[108:111], v[76:79]
    v_mfma_f32_16x16x32_bf16 v[60:63], a[80:83], v[104:107], v[60:63]
    v_mfma_f32_16x16x32_bf16 v[80:83], a[80:83], v[108:111], v[80:83]
    buffer_load_dwordx4 v[156:159], v5, s[28:31], s48 offen offset:1024 sc1
    v_mfma_f32_16x16x32_bf16 v[64:67], a[84:87], v[104:107], v[64:67]
    s_waitcnt vmcnt(11)
    v_mfma_f32_16x16x32_bf16 v[84:87], a[84:87], v[108:111], v[84:87]
    v_swap_b32 v114, v116
    v_mfma_f32_16x16x32_bf16 v[68:71], a[88:91], v[104:107], v[68:71]
    v_swap_b32 v115, v117
    v_mfma_f32_16x16x32_bf16 v[88:91], a[88:91], v[108:111], v[88:91]
    v_mfma_f32_16x16x32_bf16 v[72:75], a[92:95], v[104:107], v[72:75]
    s_add_u32 s49, s46, 266240
    buffer_load_dwordx4 v[212:215], v5, s[20:23], s49 offen offset:0 sc1
    v_mfma_f32_16x16x32_bf16 v[92:95], a[92:95], v[108:111], v[92:95]
    v_mfma_f32_16x16x32_bf16 v[56:59], a[96:99], v[112:115], v[56:59]
    s_add_u32 s48, s47, 65536
    buffer_load_dwordx4 v[160:163], v5, s[28:31], s48 offen offset:0 sc1
    v_mfma_f32_16x16x32_bf16 v[76:79], a[96:99], v[116:119], v[76:79]
    v_mfma_f32_16x16x32_bf16 v[60:63], a[100:103], v[112:115], v[60:63]
    v_mfma_f32_16x16x32_bf16 v[80:83], a[100:103], v[116:119], v[80:83]
    buffer_load_dwordx4 v[164:167], v5, s[28:31], s48 offen offset:1024 sc1
    v_mfma_f32_16x16x32_bf16 v[64:67], a[104:107], v[112:115], v[64:67]
    s_waitcnt vmcnt(12)
    v_mfma_f32_16x16x32_bf16 v[84:87], a[104:107], v[116:119], v[84:87]
    v_swap_b32 v122, v124
    v_mfma_f32_16x16x32_bf16 v[68:71], a[108:111], v[112:115], v[68:71]
    v_swap_b32 v123, v125
    v_mfma_f32_16x16x32_bf16 v[88:91], a[108:111], v[116:119], v[88:91]
    v_mfma_f32_16x16x32_bf16 v[72:75], a[112:115], v[112:115], v[72:75]
    buffer_load_dwordx4 v[216:219], v5, s[20:23], s49 offen offset:1024 sc1
    v_mfma_f32_16x16x32_bf16 v[92:95], a[112:115], v[116:119], v[92:95]
    v_mfma_f32_16x16x32_bf16 v[56:59], a[116:119], v[120:123], v[56:59]
    s_add_u32 s48, s47, 73728
    buffer_load_dwordx4 v[168:171], v5, s[28:31], s48 offen offset:0 sc1
    v_mfma_f32_16x16x32_bf16 v[76:79], a[116:119], v[124:127], v[76:79]
    v_mfma_f32_16x16x32_bf16 v[60:63], a[120:123], v[120:123], v[60:63]
    v_mfma_f32_16x16x32_bf16 v[80:83], a[120:123], v[124:127], v[80:83]
    buffer_load_dwordx4 v[172:175], v5, s[28:31], s48 offen offset:1024 sc1
    v_mfma_f32_16x16x32_bf16 v[64:67], a[124:127], v[120:123], v[64:67]
    s_waitcnt vmcnt(13)
    v_mfma_f32_16x16x32_bf16 v[84:87], a[124:127], v[124:127], v[84:87]
    v_swap_b32 v130, v132
    v_mfma_f32_16x16x32_bf16 v[68:71], a[128:131], v[120:123], v[68:71]
    v_swap_b32 v131, v133
    v_mfma_f32_16x16x32_bf16 v[88:91], a[128:131], v[124:127], v[88:91]
    v_mfma_f32_16x16x32_bf16 v[72:75], a[132:135], v[120:123], v[72:75]
    buffer_load_dwordx4 v[220:223], v5, s[20:23], s49 offen offset:2048 sc1
    v_mfma_f32_16x16x32_bf16 v[92:95], a[132:135], v[124:127], v[92:95]
    v_mfma_f32_16x16x32_bf16 v[56:59], a[136:139], v[128:131], v[56:59]
    s_add_u32 s48, s47, 81920
    buffer_load_dwordx4 v[176:179], v5, s[28:31], s48 offen offset:0 sc1
    v_mfma_f32_16x16x32_bf16 v[76:79], a[136:139], v[132:135], v[76:79]
    v_mfma_f32_16x16x32_bf16 v[60:63], a[140:143], v[128:131], v[60:63]
    v_mfma_f32_16x16x32_bf16 v[80:83], a[140:143], v[132:135], v[80:83]
    buffer_load_dwordx4 v[180:183], v5, s[28:31], s48 offen offset:1024 sc1
    v_mfma_f32_16x16x32_bf16 v[64:67], a[144:147], v[128:131], v[64:67]
    s_waitcnt vmcnt(14)
    v_mfma_f32_16x16x32_bf16 v[84:87], a[144:147], v[132:135], v[84:87]
    v_swap_b32 v138, v140
    v_mfma_f32_16x16x32_bf16 v[68:71], a[148:151], v[128:131], v[68:71]
    v_swap_b32 v139, v141
    v_mfma_f32_16x16x32_bf16 v[88:91], a[148:151], v[132:135], v[88:91]
    v_mfma_f32_16x16x32_bf16 v[72:75], a[152:155], v[128:131], v[72:75]
    buffer_load_dwordx4 v[224:227], v5, s[20:23], s49 offen offset:3072 sc1
    v_mfma_f32_16x16x32_bf16 v[92:95], a[152:155], v[132:135], v[92:95]
    v_mfma_f32_16x16x32_bf16 v[56:59], a[156:159], v[136:139], v[56:59]
    s_add_u32 s48, s47, 90112
    buffer_load_dwordx4 v[184:187], v5, s[28:31], s48 offen offset:0 sc1
    v_mfma_f32_16x16x32_bf16 v[76:79], a[156:159], v[140:143], v[76:79]
    v_mfma_f32_16x16x32_bf16 v[60:63], a[160:163], v[136:139], v[60:63]
    v_mfma_f32_16x16x32_bf16 v[80:83], a[160:163], v[140:143], v[80:83]
    buffer_load_dwordx4 v[188:191], v5, s[28:31], s48 offen offset:1024 sc1
    v_mfma_f32_16x16x32_bf16 v[64:67], a[164:167], v[136:139], v[64:67]
    s_waitcnt vmcnt(15)
    v_mfma_f32_16x16x32_bf16 v[84:87], a[164:167], v[140:143], v[84:87]
    v_swap_b32 v146, v148
    v_mfma_f32_16x16x32_bf16 v[68:71], a[168:171], v[136:139], v[68:71]
    v_swap_b32 v147, v149
    v_mfma_f32_16x16x32_bf16 v[88:91], a[168:171], v[140:143], v[88:91]
    v_mfma_f32_16x16x32_bf16 v[72:75], a[172:175], v[136:139], v[72:75]
    s_add_u32 s49, s49, 4096
    buffer_load_dwordx4 v[228:231], v5, s[20:23], s49 offen offset:0 sc1
    v_mfma_f32_16x16x32_bf16 v[92:95], a[172:175], v[140:143], v[92:95]
    v_mfma_f32_16x16x32_bf16 v[56:59], a[176:179], v[144:147], v[56:59]
    s_add_u32 s48, s47, 98304
    buffer_load_dwordx4 v[96:99], v5, s[28:31], s48 offen offset:0 sc1
    v_mfma_f32_16x16x32_bf16 v[76:79], a[176:179], v[148:151], v[76:79]
    v_mfma_f32_16x16x32_bf16 v[60:63], a[180:183], v[144:147], v[60:63]
    v_mfma_f32_16x16x32_bf16 v[80:83], a[180:183], v[148:151], v[80:83]
    buffer_load_dwordx4 v[100:103], v5, s[28:31], s48 offen offset:1024 sc1
    v_mfma_f32_16x16x32_bf16 v[64:67], a[184:187], v[144:147], v[64:67]
    s_waitcnt vmcnt(15)
    v_mfma_f32_16x16x32_bf16 v[84:87], a[184:187], v[148:151], v[84:87]
    v_swap_b32 v154, v156
    v_mfma_f32_16x16x32_bf16 v[68:71], a[188:191], v[144:147], v[68:71]
    v_swap_b32 v155, v157
    v_mfma_f32_16x16x32_bf16 v[88:91], a[188:191], v[148:151], v[88:91]
    v_mfma_f32_16x16x32_bf16 v[72:75], a[192:195], v[144:147], v[72:75]
    buffer_load_dwordx2 v[232:233], v5, s[8:11], s18 offen offset:0 sc1
    v_mfma_f32_16x16x32_bf16 v[92:95], a[192:195], v[148:151], v[92:95]
    v_mfma_f32_16x16x32_bf16 v[56:59], a[196:199], v[152:155], v[56:59]
    s_add_u32 s48, s47, 106496
    buffer_load_dwordx4 v[104:107], v5, s[28:31], s48 offen offset:0 sc1
    v_mfma_f32_16x16x32_bf16 v[76:79], a[196:199], v[156:159], v[76:79]
    v_mfma_f32_16x16x32_bf16 v[60:63], a[200:203], v[152:155], v[60:63]
    v_mfma_f32_16x16x32_bf16 v[80:83], a[200:203], v[156:159], v[80:83]
    buffer_load_dwordx4 v[108:111], v5, s[28:31], s48 offen offset:1024 sc1
    v_mfma_f32_16x16x32_bf16 v[64:67], a[204:207], v[152:155], v[64:67]
    s_waitcnt vmcnt(15)
    v_mfma_f32_16x16x32_bf16 v[84:87], a[204:207], v[156:159], v[84:87]
    v_swap_b32 v162, v164
    v_mfma_f32_16x16x32_bf16 v[68:71], a[208:211], v[152:155], v[68:71]
    v_swap_b32 v163, v165
    v_mfma_f32_16x16x32_bf16 v[88:91], a[208:211], v[156:159], v[88:91]
    v_mfma_f32_16x16x32_bf16 v[72:75], a[212:215], v[152:155], v[72:75]
    buffer_load_dwordx2 v[234:235], v5, s[8:11], s18 offen offset:1024 sc1
    v_mfma_f32_16x16x32_bf16 v[92:95], a[212:215], v[156:159], v[92:95]
    v_mfma_f32_16x16x32_bf16 v[56:59], a[216:219], v[160:163], v[56:59]
    s_add_u32 s48, s47, 0
    buffer_load_dwordx4 v[112:115], v5, s[24:27], s48 offen offset:0 sc1
    v_mfma_f32_16x16x32_bf16 v[76:79], a[216:219], v[164:167], v[76:79]
    v_mfma_f32_16x16x32_bf16 v[60:63], a[220:223], v[160:163], v[60:63]
    v_mfma_f32_16x16x32_bf16 v[80:83], a[220:223], v[164:167], v[80:83]
    buffer_load_dwordx4 v[116:119], v5, s[24:27], s48 offen offset:1024 sc1
    v_mfma_f32_16x16x32_bf16 v[64:67], a[224:227], v[160:163], v[64:67]
    s_waitcnt vmcnt(15)
    v_mfma_f32_16x16x32_bf16 v[84:87], a[224:227], v[164:167], v[84:87]
    v_swap_b32 v170, v172
    v_mfma_f32_16x16x32_bf16 v[68:71], a[228:231], v[160:163], v[68:71]
    v_swap_b32 v171, v173
    v_mfma_f32_16x16x32_bf16 v[88:91], a[228:231], v[164:167], v[88:91]
    v_mfma_f32_16x16x32_bf16 v[72:75], a[232:235], v[160:163], v[72:75]
    buffer_load_dwordx2 v[236:237], v5, s[8:11], s18 offen offset:2048 sc1
    v_mfma_f32_16x16x32_bf16 v[92:95], a[232:235], v[164:167], v[92:95]
    v_mfma_f32_16x16x32_bf16 v[56:59], a[236:239], v[168:171], v[56:59]
    s_add_u32 s48, s47, 8192
    buffer_load_dwordx4 v[120:123], v5, s[24:27], s48 offen offset:0 sc1
    v_mfma_f32_16x16x32_bf16 v[76:79], a[236:239], v[172:175], v[76:79]
    v_mfma_f32_16x16x32_bf16 v[60:63], a[240:243], v[168:171], v[60:63]
    v_mfma_f32_16x16x32_bf16 v[80:83], a[240:243], v[172:175], v[80:83]
    buffer_load_dwordx4 v[124:127], v5, s[24:27], s48 offen offset:1024 sc1
    v_mfma_f32_16x16x32_bf16 v[64:67], a[244:247], v[168:171], v[64:67]
    s_waitcnt vmcnt(15)
    v_mfma_f32_16x16x32_bf16 v[84:87], a[244:247], v[172:175], v[84:87]
    v_swap_b32 v178, v180
    v_mfma_f32_16x16x32_bf16 v[68:71], a[248:251], v[168:171], v[68:71]
    v_swap_b32 v179, v181
    v_mfma_f32_16x16x32_bf16 v[88:91], a[248:251], v[172:175], v[88:91]
    v_mfma_f32_16x16x32_bf16 v[72:75], a[252:255], v[168:171], v[72:75]
    buffer_load_dwordx2 v[238:239], v5, s[8:11], s18 offen offset:3072 sc1
    v_mfma_f32_16x16x32_bf16 v[92:95], a[252:255], v[172:175], v[92:95]
    v_mfma_f32_16x16x32_bf16 v[56:59], a[0:3], v[176:179], v[56:59]
    s_add_u32 s48, s47, 16384
    buffer_load_dwordx4 v[128:131], v5, s[24:27], s48 offen offset:0 sc1
    v_mfma_f32_16x16x32_bf16 v[76:79], a[0:3], v[180:183], v[76:79]
    v_mfma_f32_16x16x32_bf16 v[60:63], a[4:7], v[176:179], v[60:63]
    v_mfma_f32_16x16x32_bf16 v[80:83], a[4:7], v[180:183], v[80:83]
    buffer_load_dwordx4 v[132:135], v5, s[24:27], s48 offen offset:1024 sc1
    v_mfma_f32_16x16x32_bf16 v[64:67], a[8:11], v[176:179], v[64:67]
    s_waitcnt vmcnt(15)
    v_mfma_f32_16x16x32_bf16 v[84:87], a[8:11], v[180:183], v[84:87]
    v_swap_b32 v186, v188
    v_mfma_f32_16x16x32_bf16 v[68:71], a[12:15], v[176:179], v[68:71]
    v_swap_b32 v187, v189
    v_mfma_f32_16x16x32_bf16 v[88:91], a[12:15], v[180:183], v[88:91]
    v_mfma_f32_16x16x32_bf16 v[72:75], a[16:19], v[176:179], v[72:75]
    buffer_load_dwordx2 v[240:241], v5, s[8:11], s19 offen offset:0 sc1
    v_mfma_f32_16x16x32_bf16 v[92:95], a[16:19], v[180:183], v[92:95]
    v_mfma_f32_16x16x32_bf16 v[56:59], a[20:23], v[184:187], v[56:59]
    s_add_u32 s48, s47, 24576
    buffer_load_dwordx4 v[136:139], v5, s[24:27], s48 offen offset:0 sc1
    v_mfma_f32_16x16x32_bf16 v[76:79], a[20:23], v[188:191], v[76:79]
    v_mfma_f32_16x16x32_bf16 v[60:63], a[24:27], v[184:187], v[60:63]
    v_mfma_f32_16x16x32_bf16 v[80:83], a[24:27], v[188:191], v[80:83]
    buffer_load_dwordx4 v[140:143], v5, s[24:27], s48 offen offset:1024 sc1
    v_mfma_f32_16x16x32_bf16 v[64:67], a[28:31], v[184:187], v[64:67]
    s_waitcnt vmcnt(15)
    v_mfma_f32_16x16x32_bf16 v[84:87], a[28:31], v[188:191], v[84:87]
    v_swap_b32 v98, v100
    v_mfma_f32_16x16x32_bf16 v[68:71], a[32:35], v[184:187], v[68:71]
    v_swap_b32 v99, v101
    v_mfma_f32_16x16x32_bf16 v[88:91], a[32:35], v[188:191], v[88:91]
    v_mfma_f32_16x16x32_bf16 v[72:75], a[36:39], v[184:187], v[72:75]
    v_mfma_f32_16x16x32_bf16 v[92:95], a[36:39], v[188:191], v[92:95]
    v_mfma_f32_16x16x32_bf16 v[56:59], v[192:195], v[96:99], v[56:59]
    s_add_u32 s48, s47, 32768
    buffer_load_dwordx4 v[144:147], v5, s[24:27], s48 offen offset:0 sc1
    v_mfma_f32_16x16x32_bf16 v[76:79], v[192:195], v[100:103], v[76:79]
    v_mfma_f32_16x16x32_bf16 v[60:63], v[196:199], v[96:99], v[60:63]
    v_mfma_f32_16x16x32_bf16 v[80:83], v[196:199], v[100:103], v[80:83]
    buffer_load_dwordx4 v[148:151], v5, s[24:27], s48 offen offset:1024 sc1
    v_mfma_f32_16x16x32_bf16 v[64:67], v[200:203], v[96:99], v[64:67]
    s_waitcnt vmcnt(14)
    v_mfma_f32_16x16x32_bf16 v[84:87], v[200:203], v[100:103], v[84:87]
    v_swap_b32 v106, v108
    v_mfma_f32_16x16x32_bf16 v[68:71], v[204:207], v[96:99], v[68:71]
    v_swap_b32 v107, v109
    v_mfma_f32_16x16x32_bf16 v[88:91], v[204:207], v[100:103], v[88:91]
    v_mfma_f32_16x16x32_bf16 v[72:75], v[208:211], v[96:99], v[72:75]
    v_mfma_f32_16x16x32_bf16 v[92:95], v[208:211], v[100:103], v[92:95]
    v_mfma_f32_16x16x32_bf16 v[56:59], v[212:215], v[104:107], v[56:59]
    s_add_u32 s48, s47, 40960
    buffer_load_dwordx4 v[152:155], v5, s[24:27], s48 offen offset:0 sc1
    v_mfma_f32_16x16x32_bf16 v[76:79], v[212:215], v[108:111], v[76:79]
    v_mfma_f32_16x16x32_bf16 v[60:63], v[216:219], v[104:107], v[60:63]
    v_mfma_f32_16x16x32_bf16 v[80:83], v[216:219], v[108:111], v[80:83]
    buffer_load_dwordx4 v[156:159], v5, s[24:27], s48 offen offset:1024 sc1
    v_mfma_f32_16x16x32_bf16 v[64:67], v[220:223], v[104:107], v[64:67]
    s_waitcnt vmcnt(13)
    v_mfma_f32_16x16x32_bf16 v[84:87], v[220:223], v[108:111], v[84:87]
    v_swap_b32 v114, v116
    v_mfma_f32_16x16x32_bf16 v[68:71], v[224:227], v[104:107], v[68:71]
    v_swap_b32 v115, v117
    v_mfma_f32_16x16x32_bf16 v[88:91], v[224:227], v[108:111], v[88:91]
    v_mfma_f32_16x16x32_bf16 v[72:75], v[228:231], v[104:107], v[72:75]
    v_mfma_f32_16x16x32_bf16 v[92:95], v[228:231], v[108:111], v[92:95]
    v_mfma_f32_16x16x32_bf16 v[16:19], a[56:59], v[112:115], 0
    s_add_u32 s48, s47, 49152
    buffer_load_dwordx4 v[160:163], v5, s[24:27], s48 offen offset:0 sc1
    v_mfma_f32_16x16x32_bf16 v[36:39], a[56:59], v[116:119], 0
    v_mfma_f32_16x16x32_bf16 v[20:23], a[60:63], v[112:115], 0
    v_mfma_f32_16x16x32_bf16 v[40:43], a[60:63], v[116:119], 0
    buffer_load_dwordx4 v[164:167], v5, s[24:27], s48 offen offset:1024 sc1
    v_mfma_f32_16x16x32_bf16 v[24:27], a[64:67], v[112:115], 0
    s_waitcnt vmcnt(12)
    v_mfma_f32_16x16x32_bf16 v[44:47], a[64:67], v[116:119], 0
    v_swap_b32 v122, v124
    v_mfma_f32_16x16x32_bf16 v[28:31], a[68:71], v[112:115], 0
    v_swap_b32 v123, v125
    v_mfma_f32_16x16x32_bf16 v[48:51], a[68:71], v[116:119], 0
    v_mfma_f32_16x16x32_bf16 v[32:35], a[72:75], v[112:115], 0
    v_mfma_f32_16x16x32_bf16 v[52:55], a[72:75], v[116:119], 0
    v_mfma_f32_16x16x32_bf16 v[16:19], a[76:79], v[120:123], v[16:19]
    s_add_u32 s48, s47, 57344
    buffer_load_dwordx4 v[168:171], v5, s[24:27], s48 offen offset:0 sc1
    v_mfma_f32_16x16x32_bf16 v[36:39], a[76:79], v[124:127], v[36:39]
    ds_write_b128 v7, v[56:59] offset:0
    v_mfma_f32_16x16x32_bf16 v[20:23], a[80:83], v[120:123], v[20:23]
    ds_write_b128 v7, v[60:63] offset:1024
    v_mfma_f32_16x16x32_bf16 v[40:43], a[80:83], v[124:127], v[40:43]
    buffer_load_dwordx4 v[172:175], v5, s[24:27], s48 offen offset:1024 sc1
    v_mfma_f32_16x16x32_bf16 v[24:27], a[84:87], v[120:123], v[24:27]
    s_waitcnt vmcnt(11)
    v_mfma_f32_16x16x32_bf16 v[44:47], a[84:87], v[124:127], v[44:47]
    v_swap_b32 v130, v132
    v_mfma_f32_16x16x32_bf16 v[28:31], a[88:91], v[120:123], v[28:31]
    v_swap_b32 v131, v133
    v_mfma_f32_16x16x32_bf16 v[48:51], a[88:91], v[124:127], v[48:51]
    ds_write_b128 v7, v[64:67] offset:2048
    v_mfma_f32_16x16x32_bf16 v[32:35], a[92:95], v[120:123], v[32:35]
    ds_write_b128 v7, v[68:71] offset:3072
    v_mfma_f32_16x16x32_bf16 v[52:55], a[92:95], v[124:127], v[52:55]
    ds_write_b128 v7, v[72:75] offset:4096
    v_mfma_f32_16x16x32_bf16 v[16:19], a[96:99], v[128:131], v[16:19]
    s_add_u32 s48, s47, 65536
    buffer_load_dwordx4 v[176:179], v5, s[24:27], s48 offen offset:0 sc1
    v_mfma_f32_16x16x32_bf16 v[36:39], a[96:99], v[132:135], v[36:39]
    ds_write_b128 v8, v[76:79] offset:0
    v_mfma_f32_16x16x32_bf16 v[20:23], a[100:103], v[128:131], v[20:23]
    ds_write_b128 v8, v[80:83] offset:1024
    v_mfma_f32_16x16x32_bf16 v[40:43], a[100:103], v[132:135], v[40:43]
    buffer_load_dwordx4 v[180:183], v5, s[24:27], s48 offen offset:1024 sc1
    v_mfma_f32_16x16x32_bf16 v[24:27], a[104:107], v[128:131], v[24:27]
    s_waitcnt vmcnt(10)
    v_mfma_f32_16x16x32_bf16 v[44:47], a[104:107], v[132:135], v[44:47]
    v_swap_b32 v138, v140
    v_mfma_f32_16x16x32_bf16 v[28:31], a[108:111], v[128:131], v[28:31]
    v_swap_b32 v139, v141
    v_mfma_f32_16x16x32_bf16 v[48:51], a[108:111], v[132:135], v[48:51]
    ds_write_b128 v8, v[84:87] offset:2048
    v_mfma_f32_16x16x32_bf16 v[32:35], a[112:115], v[128:131], v[32:35]
    ds_write_b128 v8, v[88:91] offset:3072
    v_mfma_f32_16x16x32_bf16 v[52:55], a[112:115], v[132:135], v[52:55]
    ds_write_b128 v8, v[92:95] offset:4096
    v_mfma_f32_16x16x32_bf16 v[16:19], a[116:119], v[136:139], v[16:19]
    s_add_u32 s48, s47, 73728
    buffer_load_dwordx4 v[184:187], v5, s[24:27], s48 offen offset:0 sc1
    v_mfma_f32_16x16x32_bf16 v[36:39], a[116:119], v[140:143], v[36:39]
    v_mfma_f32_16x16x32_bf16 v[20:23], a[120:123], v[136:139], v[20:23]
    v_mfma_f32_16x16x32_bf16 v[40:43], a[120:123], v[140:143], v[40:43]
    buffer_load_dwordx4 v[188:191], v5, s[24:27], s48 offen offset:1024 sc1
    v_mfma_f32_16x16x32_bf16 v[24:27], a[124:127], v[136:139], v[24:27]
    s_waitcnt vmcnt(10)
    v_mfma_f32_16x16x32_bf16 v[44:47], a[124:127], v[140:143], v[44:47]
    v_swap_b32 v146, v148
    v_mfma_f32_16x16x32_bf16 v[28:31], a[128:131], v[136:139], v[28:31]
    v_swap_b32 v147, v149
    v_mfma_f32_16x16x32_bf16 v[48:51], a[128:131], v[140:143], v[48:51]
    v_mfma_f32_16x16x32_bf16 v[32:35], a[132:135], v[136:139], v[32:35]
    v_mfma_f32_16x16x32_bf16 v[52:55], a[132:135], v[140:143], v[52:55]
    v_mfma_f32_16x16x32_bf16 v[16:19], a[136:139], v[144:147], v[16:19]
    s_add_u32 s48, s47, 81920
    buffer_load_dwordx4 v[96:99], v5, s[24:27], s48 offen offset:0 sc1
    v_mfma_f32_16x16x32_bf16 v[36:39], a[136:139], v[148:151], v[36:39]
    v_mfma_f32_16x16x32_bf16 v[20:23], a[140:143], v[144:147], v[20:23]
    v_mfma_f32_16x16x32_bf16 v[40:43], a[140:143], v[148:151], v[40:43]
    buffer_load_dwordx4 v[100:103], v5, s[24:27], s48 offen offset:1024 sc1
    v_mfma_f32_16x16x32_bf16 v[24:27], a[144:147], v[144:147], v[24:27]
    s_waitcnt vmcnt(10)
    v_mfma_f32_16x16x32_bf16 v[44:47], a[144:147], v[148:151], v[44:47]
    v_swap_b32 v154, v156
    v_mfma_f32_16x16x32_bf16 v[28:31], a[148:151], v[144:147], v[28:31]
    v_swap_b32 v155, v157
    v_mfma_f32_16x16x32_bf16 v[48:51], a[148:151], v[148:151], v[48:51]
    v_mfma_f32_16x16x32_bf16 v[32:35], a[152:155], v[144:147], v[32:35]
    v_mfma_f32_16x16x32_bf16 v[52:55], a[152:155], v[148:151], v[52:55]
    s_waitcnt lgkmcnt(0)
    s_barrier
    v_mfma_f32_16x16x32_bf16 v[16:19], a[156:159], v[152:155], v[16:19]
    s_add_u32 s48, s47, 90112
    buffer_load_dwordx4 v[104:107], v5, s[24:27], s48 offen offset:0 sc1
    v_mfma_f32_16x16x32_bf16 v[36:39], a[156:159], v[156:159], v[36:39]
    ds_read_b128 v[56:59], v9 offset:10240
    v_mfma_f32_16x16x32_bf16 v[20:23], a[160:163], v[152:155], v[20:23]
    ds_read_b128 v[60:63], v9 offset:11264
    v_mfma_f32_16x16x32_bf16 v[40:43], a[160:163], v[156:159], v[40:43]
    buffer_load_dwordx4 v[108:111], v5, s[24:27], s48 offen offset:1024 sc1
    v_mfma_f32_16x16x32_bf16 v[24:27], a[164:167], v[152:155], v[24:27]
    s_waitcnt vmcnt(10)
    v_mfma_f32_16x16x32_bf16 v[44:47], a[164:167], v[156:159], v[44:47]
    v_swap_b32 v162, v164
    v_mfma_f32_16x16x32_bf16 v[28:31], a[168:171], v[152:155], v[28:31]
    v_swap_b32 v163, v165
    v_mfma_f32_16x16x32_bf16 v[48:51], a[168:171], v[156:159], v[48:51]
    ds_read_b128 v[64:67], v9 offset:12288
    v_mfma_f32_16x16x32_bf16 v[32:35], a[172:175], v[152:155], v[32:35]
    ds_read_b128 v[68:71], v9 offset:13312
    v_mfma_f32_16x16x32_bf16 v[52:55], a[172:175], v[156:159], v[52:55]
    ds_read_b128 v[72:75], v9 offset:14336
    v_mfma_f32_16x16x32_bf16 v[16:19], a[176:179], v[160:163], v[16:19]
    s_add_u32 s48, s47, 98304
    buffer_load_dwordx4 v[112:115], v5, s[24:27], s48 offen offset:0 sc1
    v_mfma_f32_16x16x32_bf16 v[36:39], a[176:179], v[164:167], v[36:39]
    ds_read_b128 v[76:79], v9 offset:15360
    v_mfma_f32_16x16x32_bf16 v[20:23], a[180:183], v[160:163], v[20:23]
    ds_read_b128 v[80:83], v9 offset:16384
    v_mfma_f32_16x16x32_bf16 v[40:43], a[180:183], v[164:167], v[40:43]
    buffer_load_dwordx4 v[116:119], v5, s[24:27], s48 offen offset:1024 sc1
    v_mfma_f32_16x16x32_bf16 v[24:27], a[184:187], v[160:163], v[24:27]
    s_waitcnt vmcnt(10)
    v_mfma_f32_16x16x32_bf16 v[44:47], a[184:187], v[164:167], v[44:47]
    v_swap_b32 v170, v172
    v_mfma_f32_16x16x32_bf16 v[28:31], a[188:191], v[160:163], v[28:31]
    v_swap_b32 v171, v173
    v_mfma_f32_16x16x32_bf16 v[48:51], a[188:191], v[164:167], v[48:51]
    ds_read_b128 v[84:87], v9 offset:17408
    v_mfma_f32_16x16x32_bf16 v[32:35], a[192:195], v[160:163], v[32:35]
    ds_read_b128 v[88:91], v9 offset:18432
    v_mfma_f32_16x16x32_bf16 v[52:55], a[192:195], v[164:167], v[52:55]
    ds_read_b128 v[92:95], v9 offset:19456
    s_waitcnt vmcnt(20) lgkmcnt(0)
    v_mfma_f32_16x16x32_bf16 v[16:19], a[196:199], v[168:171], v[16:19]
    s_add_u32 s48, s47, 106496
    buffer_load_dwordx4 v[120:123], v5, s[24:27], s48 offen offset:0 sc1
    v_mfma_f32_16x16x32_bf16 v[36:39], a[196:199], v[172:175], v[36:39]
    v_add_f32 v56, v56, v76
    v_add_f32 v57, v57, v77
    v_mfma_f32_16x16x32_bf16 v[20:23], a[200:203], v[168:171], v[20:23]
    v_add_f32 v58, v58, v78
    v_add_f32 v59, v59, v79
    v_mfma_f32_16x16x32_bf16 v[40:43], a[200:203], v[172:175], v[40:43]
    buffer_load_dwordx4 v[124:127], v5, s[24:27], s48 offen offset:1024 sc1
    v_mfma_f32_16x16x32_bf16 v[24:27], a[204:207], v[168:171], v[24:27]
    s_waitcnt vmcnt(10)
    v_mfma_f32_16x16x32_bf16 v[44:47], a[204:207], v[172:175], v[44:47]
    v_swap_b32 v178, v180
    v_mfma_f32_16x16x32_bf16 v[28:31], a[208:211], v[168:171], v[28:31]
    v_swap_b32 v179, v181
    v_mfma_f32_16x16x32_bf16 v[48:51], a[208:211], v[172:175], v[48:51]
    v_add_f32 v60, v60, v80
    v_add_f32 v61, v61, v81
    v_mfma_f32_16x16x32_bf16 v[32:35], a[212:215], v[168:171], v[32:35]
    v_add_f32 v62, v62, v82
    v_add_f32 v63, v63, v83
    v_mfma_f32_16x16x32_bf16 v[52:55], a[212:215], v[172:175], v[52:55]
    v_add_f32 v64, v64, v84
    v_add_f32 v65, v65, v85
    v_mfma_f32_16x16x32_bf16 v[16:19], a[216:219], v[176:179], v[16:19]
    v_add_f32 v66, v66, v86
    v_add_f32 v67, v67, v87
    v_mfma_f32_16x16x32_bf16 v[36:39], a[216:219], v[180:183], v[36:39]
    v_add_f32 v68, v68, v88
    v_add_f32 v69, v69, v89
    v_mfma_f32_16x16x32_bf16 v[20:23], a[220:223], v[176:179], v[20:23]
    v_add_f32 v70, v70, v90
    v_add_f32 v71, v71, v91
    v_mfma_f32_16x16x32_bf16 v[40:43], a[220:223], v[180:183], v[40:43]
    v_add_f32 v72, v72, v92
    v_add_f32 v73, v73, v93
    v_mfma_f32_16x16x32_bf16 v[24:27], a[224:227], v[176:179], v[24:27]
    s_waitcnt vmcnt(8)
    v_mfma_f32_16x16x32_bf16 v[44:47], a[224:227], v[180:183], v[44:47]
    v_swap_b32 v186, v188
    v_mfma_f32_16x16x32_bf16 v[28:31], a[228:231], v[176:179], v[28:31]
    v_swap_b32 v187, v189
    v_mfma_f32_16x16x32_bf16 v[48:51], a[228:231], v[180:183], v[48:51]
    v_add_f32 v74, v74, v94
    v_add_f32 v75, v75, v95
    v_mfma_f32_16x16x32_bf16 v[32:35], a[232:235], v[176:179], v[32:35]
    v_lshlrev_b32 v76, 16, v232
    v_and_b32 v77, 0xffff0000, v232
    v_mfma_f32_16x16x32_bf16 v[52:55], a[232:235], v[180:183], v[52:55]
    v_lshlrev_b32 v78, 16, v233
    v_and_b32 v79, 0xffff0000, v233
    v_mfma_f32_16x16x32_bf16 v[16:19], a[236:239], v[184:187], v[16:19]
    v_lshlrev_b32 v80, 16, v234
    v_and_b32 v81, 0xffff0000, v234
    v_mfma_f32_16x16x32_bf16 v[36:39], a[236:239], v[188:191], v[36:39]
    v_lshlrev_b32 v82, 16, v235
    v_and_b32 v83, 0xffff0000, v235
    v_mfma_f32_16x16x32_bf16 v[20:23], a[240:243], v[184:187], v[20:23]
    v_lshlrev_b32 v84, 16, v236
    v_and_b32 v85, 0xffff0000, v236
    v_mfma_f32_16x16x32_bf16 v[40:43], a[240:243], v[188:191], v[40:43]
    v_lshlrev_b32 v86, 16, v237
    v_and_b32 v87, 0xffff0000, v237
    v_mfma_f32_16x16x32_bf16 v[24:27], a[244:247], v[184:187], v[24:27]
    s_waitcnt vmcnt(6)
    v_mfma_f32_16x16x32_bf16 v[44:47], a[244:247], v[188:191], v[44:47]
    v_swap_b32 v98, v100
    v_mfma_f32_16x16x32_bf16 v[28:31], a[248:251], v[184:187], v[28:31]
    v_swap_b32 v99, v101
    v_mfma_f32_16x16x32_bf16 v[48:51], a[248:251], v[188:191], v[48:51]
    v_lshlrev_b32 v88, 16, v238
    v_and_b32 v89, 0xffff0000, v238
    v_mfma_f32_16x16x32_bf16 v[32:35], a[252:255], v[184:187], v[32:35]
    v_lshlrev_b32 v90, 16, v239
    v_and_b32 v91, 0xffff0000, v239
    v_mfma_f32_16x16x32_bf16 v[52:55], a[252:255], v[188:191], v[52:55]
    v_lshlrev_b32 v92, 16, v240
    v_and_b32 v93, 0xffff0000, v240
    s_bitcmp1_b32 s3, 0
    s_cbranch_scc1 Lodd_32
    v_mfma_f32_16x16x32_bf16 v[36:39], a[0:3], v[100:103], v[36:39]
    s_waitcnt vmcnt(4)
    v_lshlrev_b32 v94, 16, v241
    v_and_b32 v95, 0xffff0000, v241
    v_mfma_f32_16x16x32_bf16 v[40:43], a[4:7], v[100:103], v[40:43]
    v_swap_b32 v106, v108
    v_mfma_f32_16x16x32_bf16 v[44:47], a[8:11], v[100:103], v[44:47]
    v_swap_b32 v107, v109
    v_mfma_f32_16x16x32_bf16 v[48:51], a[12:15], v[100:103], v[48:51]
    v_fma_f32 v56, v56, v12, v76
    v_fma_f32 v57, v57, v12, v77
    v_mfma_f32_16x16x32_bf16 v[52:55], a[16:19], v[100:103], v[52:55]
    v_fma_f32 v58, v58, v12, v78
    v_fma_f32 v59, v59, v12, v79
    v_mfma_f32_16x16x32_bf16 v[36:39], a[20:23], v[108:111], v[36:39]
    s_waitcnt vmcnt(2)
    v_fma_f32 v60, v60, v12, v80
    v_fma_f32 v61, v61, v12, v81
    v_mfma_f32_16x16x32_bf16 v[40:43], a[24:27], v[108:111], v[40:43]
    v_swap_b32 v114, v116
    v_mfma_f32_16x16x32_bf16 v[44:47], a[28:31], v[108:111], v[44:47]
    v_swap_b32 v115, v117
    v_mfma_f32_16x16x32_bf16 v[48:51], a[32:35], v[108:111], v[48:51]
    v_fma_f32 v62, v62, v12, v82
    v_fma_f32 v63, v63, v12, v83
    v_mfma_f32_16x16x32_bf16 v[52:55], a[36:39], v[108:111], v[52:55]
    v_fma_f32 v64, v64, v12, v84
    v_fma_f32 v65, v65, v12, v85
    v_mfma_f32_16x16x32_bf16 v[36:39], v[192:195], v[116:119], v[36:39]
    s_waitcnt vmcnt(0)
    v_fma_f32 v66, v66, v12, v86
    v_fma_f32 v67, v67, v12, v87
    v_mfma_f32_16x16x32_bf16 v[40:43], v[196:199], v[116:119], v[40:43]
    v_swap_b32 v122, v124
    v_mfma_f32_16x16x32_bf16 v[44:47], v[200:203], v[116:119], v[44:47]
    v_swap_b32 v123, v125
    v_mfma_f32_16x16x32_bf16 v[48:51], v[204:207], v[116:119], v[48:51]
    v_fma_f32 v68, v68, v12, v88
    v_fma_f32 v69, v69, v12, v89
    v_mfma_f32_16x16x32_bf16 v[52:55], v[208:211], v[116:119], v[52:55]
    v_fma_f32 v70, v70, v12, v90
    v_fma_f32 v71, v71, v12, v91
    v_mfma_f32_16x16x32_bf16 v[36:39], v[212:215], v[124:127], v[36:39]
    v_fma_f32 v72, v72, v12, v92
    v_fma_f32 v73, v73, v12, v93
    v_mfma_f32_16x16x32_bf16 v[40:43], v[216:219], v[124:127], v[40:43]
    v_fma_f32 v74, v74, v12, v94
    v_fma_f32 v75, v75, v12, v95
    v_mfma_f32_16x16x32_bf16 v[44:47], v[220:223], v[124:127], v[44:47]
    v_mfma_f32_16x16x32_bf16 v[48:51], v[224:227], v[124:127], v[48:51]
    v_mfma_f32_16x16x32_bf16 v[52:55], v[228:231], v[124:127], v[52:55]
    s_cmp_lg_u32 s3, 0
    s_cbranch_scc1 Lfb_34
    s_mov_b64 exec, 1
    buffer_store_dword v14, v15, s[64:67], s61 offen sc1
    s_mov_b64 exec, -1
Lfb_34:
    v_mfma_f32_16x16x32_bf16 v[16:19], a[0:3], v[96:99], v[16:19]
    v_mfma_f32_16x16x32_bf16 v[20:23], a[4:7], v[96:99], v[20:23]
    ds_write_b128 v6, v[36:39] offset:0
    v_mfma_f32_16x16x32_bf16 v[24:27], a[8:11], v[96:99], v[24:27]
    ds_write_b128 v6, v[40:43] offset:1024
    v_mfma_f32_16x16x32_bf16 v[28:31], a[12:15], v[96:99], v[28:31]
    ds_write_b128 v6, v[44:47] offset:2048
    v_mfma_f32_16x16x32_bf16 v[32:35], a[16:19], v[96:99], v[32:35]
    ds_write_b128 v6, v[48:51] offset:3072
    v_mfma_f32_16x16x32_bf16 v[16:19], a[20:23], v[104:107], v[16:19]
    ds_write_b128 v6, v[52:55] offset:4096
    v_mfma_f32_16x16x32_bf16 v[20:23], a[24:27], v[104:107], v[20:23]
    v_mfma_f32_16x16x32_bf16 v[24:27], a[28:31], v[104:107], v[24:27]
    v_mfma_f32_16x16x32_bf16 v[28:31], a[32:35], v[104:107], v[28:31]
    v_mfma_f32_16x16x32_bf16 v[32:35], a[36:39], v[104:107], v[32:35]
    v_mfma_f32_16x16x32_bf16 v[16:19], v[192:195], v[112:115], v[16:19]
    v_mfma_f32_16x16x32_bf16 v[20:23], v[196:199], v[112:115], v[20:23]
    v_mfma_f32_16x16x32_bf16 v[24:27], v[200:203], v[112:115], v[24:27]
    v_mfma_f32_16x16x32_bf16 v[28:31], v[204:207], v[112:115], v[28:31]
    v_mfma_f32_16x16x32_bf16 v[32:35], v[208:211], v[112:115], v[32:35]
    s_waitcnt lgkmcnt(0)
    s_barrier
    v_mfma_f32_16x16x32_bf16 v[16:19], v[212:215], v[120:123], v[16:19]
    ds_read_b128 v[128:131], v9 offset:5120
    v_mfma_f32_16x16x32_bf16 v[20:23], v[216:219], v[120:123], v[20:23]
    ds_read_b128 v[132:135], v9 offset:6144
    v_mfma_f32_16x16x32_bf16 v[24:27], v[220:223], v[120:123], v[24:27]
    ds_read_b128 v[136:139], v9 offset:7168
    v_mfma_f32_16x16x32_bf16 v[28:31], v[224:227], v[120:123], v[28:31]
    ds_read_b128 v[140:143], v9 offset:8192
    v_mfma_f32_16x16x32_bf16 v[32:35], v[228:231], v[120:123], v[32:35]
    ds_read_b128 v[144:147], v9 offset:9216
    s_waitcnt lgkmcnt(0)
    s_nop 0
    v_pk_fma_f32 v[56:57], v[128:129], v[12:13], v[56:57] op_sel_hi:[1,0,1]
    v_pk_fma_f32 v[58:59], v[130:131], v[12:13], v[58:59] op_sel_hi:[1,0,1]
    v_pk_fma_f32 v[60:61], v[132:133], v[12:13], v[60:61] op_sel_hi:[1,0,1]
    v_pk_fma_f32 v[62:63], v[134:135], v[12:13], v[62:63] op_sel_hi:[1,0,1]
    v_pk_fma_f32 v[64:65], v[136:137], v[12:13], v[64:65] op_sel_hi:[1,0,1]
    v_pk_fma_f32 v[66:67], v[138:139], v[12:13], v[66:67] op_sel_hi:[1,0,1]
    v_pk_fma_f32 v[68:69], v[140:141], v[12:13], v[68:69] op_sel_hi:[1,0,1]
    v_pk_fma_f32 v[70:71], v[142:143], v[12:13], v[70:71] op_sel_hi:[1,0,1]
    v_pk_fma_f32 v[72:73], v[144:145], v[12:13], v[72:73] op_sel_hi:[1,0,1]
    v_pk_fma_f32 v[74:75], v[146:147], v[12:13], v[74:75] op_sel_hi:[1,0,1]
    v_pk_fma_f32 v[16:17], v[16:17], v[12:13], v[56:57] op_sel_hi:[1,0,1]
    v_pk_fma_f32 v[18:19], v[18:19], v[12:13], v[58:59] op_sel_hi:[1,0,1]
    v_cvt_pk_bf16_f32 v128, v16, v17
    v_cvt_pk_bf16_f32 v129, v18, v19
    v_pk_fma_f32 v[20:21], v[20:21], v[12:13], v[60:61] op_sel_hi:[1,0,1]
    v_pk_fma_f32 v[22:23], v[22:23], v[12:13], v[62:63] op_sel_hi:[1,0,1]
    v_cvt_pk_bf16_f32 v130, v20, v21
    v_cvt_pk_bf16_f32 v131, v22, v23
    s_nop 0
    v_permlane16_swap_b32 v128, v130
    v_permlane16_swap_b32 v129, v131
    s_nop 0
    buffer_store_dwordx4 v[128:131], v11, s[12:15], s50 offen offset:0
    v_pk_fma_f32 v[24:25], v[24:25], v[12:13], v[64:65] op_sel_hi:[1,0,1]
    v_pk_fma_f32 v[26:27], v[26:27], v[12:13], v[66:67] op_sel_hi:[1,0,1]
    v_cvt_pk_bf16_f32 v132, v24, v25
    v_cvt_pk_bf16_f32 v133, v26, v27
    v_pk_fma_f32 v[28:29], v[28:29], v[12:13], v[68:69] op_sel_hi:[1,0,1]
    v_pk_fma_f32 v[30:31], v[30:31], v[12:13], v[70:71] op_sel_hi:[1,0,1]
    v_cvt_pk_bf16_f32 v134, v28, v29
    v_cvt_pk_bf16_f32 v135, v30, v31
    s_nop 0
    v_permlane16_swap_b32 v132, v134
    v_permlane16_swap_b32 v133, v135
    s_nop 0
    buffer_store_dwordx4 v[132:135], v11, s[12:15], s50 offen offset:64
    v_pk_fma_f32 v[32:33], v[32:33], v[12:13], v[72:73] op_sel_hi:[1,0,1]
    v_pk_fma_f32 v[34:35], v[34:35], v[12:13], v[74:75] op_sel_hi:[1,0,1]
    v_cvt_pk_bf16_f32 v136, v32, v33
    v_cvt_pk_bf16_f32 v137, v34, v35
    buffer_store_dwordx2 v[136:137], v10, s[12:15], s50 offen offset:128
    s_branch Lfin_33
Lodd_32:
    v_mfma_f32_16x16x32_bf16 v[16:19], a[0:3], v[96:99], v[16:19]
    s_waitcnt vmcnt(4)
    v_lshlrev_b32 v94, 16, v241
    v_and_b32 v95, 0xffff0000, v241
    v_mfma_f32_16x16x32_bf16 v[20:23], a[4:7], v[96:99], v[20:23]
    v_swap_b32 v106, v108
    v_mfma_f32_16x16x32_bf16 v[24:27], a[8:11], v[96:99], v[24:27]
    v_swap_b32 v107, v109
    v_mfma_f32_16x16x32_bf16 v[28:31], a[12:15], v[96:99], v[28:31]
    v_fma_f32 v56, v56, v12, v76
    v_fma_f32 v57, v57, v12, v77
    v_mfma_f32_16x16x32_bf16 v[32:35], a[16:19], v[96:99], v[32:35]
    v_fma_f32 v58, v58, v12, v78
    v_fma_f32 v59, v59, v12, v79
    v_mfma_f32_16x16x32_bf16 v[16:19], a[20:23], v[104:107], v[16:19]
    s_waitcnt vmcnt(2)
    v_fma_f32 v60, v60, v12, v80
    v_fma_f32 v61, v61, v12, v81
    v_mfma_f32_16x16x32_bf16 v[20:23], a[24:27], v[104:107], v[20:23]
    v_swap_b32 v114, v116
    v_mfma_f32_16x16x32_bf16 v[24:27], a[28:31], v[104:107], v[24:27]
    v_swap_b32 v115, v117
    v_mfma_f32_16x16x32_bf16 v[28:31], a[32:35], v[104:107], v[28:31]
    v_fma_f32 v62, v62, v12, v82
    v_fma_f32 v63, v63, v12, v83
    v_mfma_f32_16x16x32_bf16 v[32:35], a[36:39], v[104:107], v[32:35]
    v_fma_f32 v64, v64, v12, v84
    v_fma_f32 v65, v65, v12, v85
    v_mfma_f32_16x16x32_bf16 v[16:19], v[192:195], v[112:115], v[16:19]
    s_waitcnt vmcnt(0)
    v_fma_f32 v66, v66, v12, v86
    v_fma_f32 v67, v67, v12, v87
    v_mfma_f32_16x16x32_bf16 v[20:23], v[196:199], v[112:115], v[20:23]
    v_swap_b32 v122, v124
    v_mfma_f32_16x16x32_bf16 v[24:27], v[200:203], v[112:115], v[24:27]
    v_swap_b32 v123, v125
    v_mfma_f32_16x16x32_bf16 v[28:31], v[204:207], v[112:115], v[28:31]
    v_fma_f32 v68, v68, v12, v88
    v_fma_f32 v69, v69, v12, v89
    v_mfma_f32_16x16x32_bf16 v[32:35], v[208:211], v[112:115], v[32:35]
    v_fma_f32 v70, v70, v12, v90
    v_fma_f32 v71, v71, v12, v91
    v_mfma_f32_16x16x32_bf16 v[16:19], v[212:215], v[120:123], v[16:19]
    v_fma_f32 v72, v72, v12, v92
    v_fma_f32 v73, v73, v12, v93
    v_mfma_f32_16x16x32_bf16 v[20:23], v[216:219], v[120:123], v[20:23]
    v_fma_f32 v74, v74, v12, v94
    v_fma_f32 v75, v75, v12, v95
    v_mfma_f32_16x16x32_bf16 v[24:27], v[220:223], v[120:123], v[24:27]
    v_mfma_f32_16x16x32_bf16 v[28:31], v[224:227], v[120:123], v[28:31]
    v_mfma_f32_16x16x32_bf16 v[32:35], v[228:231], v[120:123], v[32:35]
    v_mfma_f32_16x16x32_bf16 v[36:39], a[0:3], v[100:103], v[36:39]
    v_mfma_f32_16x16x32_bf16 v[40:43], a[4:7], v[100:103], v[40:43]
    ds_write_b128 v6, v[16:19] offset:0
    v_mfma_f32_16x16x32_bf16 v[44:47], a[8:11], v[100:103], v[44:47]
    ds_write_b128 v6, v[20:23] offset:1024
    v_mfma_f32_16x16x32_bf16 v[48:51], a[12:15], v[100:103], v[48:51]
    ds_write_b128 v6, v[24:27] offset:2048
    v_mfma_f32_16x16x32_bf16 v[52:55], a[16:19], v[100:103], v[52:55]
    ds_write_b128 v6, v[28:31] offset:3072
    v_mfma_f32_16x16x32_bf16 v[36:39], a[20:23], v[108:111], v[36:39]
    ds_write_b128 v6, v[32:35] offset:4096
    v_mfma_f32_16x16x32_bf16 v[40:43], a[24:27], v[108:111], v[40:43]
    v_mfma_f32_16x16x32_bf16 v[44:47], a[28:31], v[108:111], v[44:47]
    v_mfma_f32_16x16x32_bf16 v[48:51], a[32:35], v[108:111], v[48:51]
    v_mfma_f32_16x16x32_bf16 v[52:55], a[36:39], v[108:111], v[52:55]
    v_mfma_f32_16x16x32_bf16 v[36:39], v[192:195], v[116:119], v[36:39]
    v_mfma_f32_16x16x32_bf16 v[40:43], v[196:199], v[116:119], v[40:43]
    v_mfma_f32_16x16x32_bf16 v[44:47], v[200:203], v[116:119], v[44:47]
    v_mfma_f32_16x16x32_bf16 v[48:51], v[204:207], v[116:119], v[48:51]
    v_mfma_f32_16x16x32_bf16 v[52:55], v[208:211], v[116:119], v[52:55]
    s_waitcnt lgkmcnt(0)
    s_barrier
    v_mfma_f32_16x16x32_bf16 v[36:39], v[212:215], v[124:127], v[36:39]
    ds_read_b128 v[128:131], v9 offset:5120
    v_mfma_f32_16x16x32_bf16 v[40:43], v[216:219], v[124:127], v[40:43]
    ds_read_b128 v[132:135], v9 offset:6144
    v_mfma_f32_16x16x32_bf16 v[44:47], v[220:223], v[124:127], v[44:47]
    ds_read_b128 v[136:139], v9 offset:7168
    v_mfma_f32_16x16x32_bf16 v[48:51], v[224:227], v[124:127], v[48:51]
    ds_read_b128 v[140:143], v9 offset:8192
    v_mfma_f32_16x16x32_bf16 v[52:55], v[228:231], v[124:127], v[52:55]
    ds_read_b128 v[144:147], v9 offset:9216
    s_waitcnt lgkmcnt(0)
    v_pk_fma_f32 v[56:57], v[128:129], v[12:13], v[56:57] op_sel_hi:[1,0,1]
    v_pk_fma_f32 v[58:59], v[130:131], v[12:13], v[58:59] op_sel_hi:[1,0,1]
    v_pk_fma_f32 v[60:61], v[132:133], v[12:13], v[60:61] op_sel_hi:[1,0,1]
    v_pk_fma_f32 v[62:63], v[134:135], v[12:13], v[62:63] op_sel_hi:[1,0,1]
    v_pk_fma_f32 v[64:65], v[136:137], v[12:13], v[64:65] op_sel_hi:[1,0,1]
    v_pk_fma_f32 v[66:67], v[138:139], v[12:13], v[66:67] op_sel_hi:[1,0,1]
    v_pk_fma_f32 v[68:69], v[140:141], v[12:13], v[68:69] op_sel_hi:[1,0,1]
    v_pk_fma_f32 v[70:71], v[142:143], v[12:13], v[70:71] op_sel_hi:[1,0,1]
    v_pk_fma_f32 v[72:73], v[144:145], v[12:13], v[72:73] op_sel_hi:[1,0,1]
    v_pk_fma_f32 v[74:75], v[146:147], v[12:13], v[74:75] op_sel_hi:[1,0,1]
    v_pk_fma_f32 v[36:37], v[36:37], v[12:13], v[56:57] op_sel_hi:[1,0,1]
    v_pk_fma_f32 v[38:39], v[38:39], v[12:13], v[58:59] op_sel_hi:[1,0,1]
    v_cvt_pk_bf16_f32 v128, v36, v37
    v_cvt_pk_bf16_f32 v129, v38, v39
    v_pk_fma_f32 v[40:41], v[40:41], v[12:13], v[60:61] op_sel_hi:[1,0,1]
    v_pk_fma_f32 v[42:43], v[42:43], v[12:13], v[62:63] op_sel_hi:[1,0,1]
    v_cvt_pk_bf16_f32 v130, v40, v41
    v_cvt_pk_bf16_f32 v131, v42, v43
    s_nop 0
    v_permlane16_swap_b32 v128, v130
    v_permlane16_swap_b32 v129, v131
    s_nop 0
    buffer_store_dwordx4 v[128:131], v11, s[12:15], s50 offen offset:0
    v_pk_fma_f32 v[44:45], v[44:45], v[12:13], v[64:65] op_sel_hi:[1,0,1]
    v_pk_fma_f32 v[46:47], v[46:47], v[12:13], v[66:67] op_sel_hi:[1,0,1]
    v_cvt_pk_bf16_f32 v132, v44, v45
    v_cvt_pk_bf16_f32 v133, v46, v47
    v_pk_fma_f32 v[48:49], v[48:49], v[12:13], v[68:69] op_sel_hi:[1,0,1]
    v_pk_fma_f32 v[50:51], v[50:51], v[12:13], v[70:71] op_sel_hi:[1,0,1]
    v_cvt_pk_bf16_f32 v134, v48, v49
    v_cvt_pk_bf16_f32 v135, v50, v51
    s_nop 0
    v_permlane16_swap_b32 v132, v134
    v_permlane16_swap_b32 v133, v135
    s_nop 0
    buffer_store_dwordx4 v[132:135], v11, s[12:15], s50 offen offset:64
    v_pk_fma_f32 v[52:53], v[52:53], v[12:13], v[72:73] op_sel_hi:[1,0,1]
    v_pk_fma_f32 v[54:55], v[54:55], v[12:13], v[74:75] op_sel_hi:[1,0,1]
    v_cvt_pk_bf16_f32 v136, v52, v53
    v_cvt_pk_bf16_f32 v137, v54, v55
    buffer_store_dwordx2 v[136:137], v10, s[12:15], s50 offen offset:128
Lfin_33:
L_END:
    s_endpgm

.section .rodata,"a"
.p2align 6
.amdhsa_kernel sequential_preLN__ssm_conv_s4__dense_activation_relu__prompt_kernel
  .amdhsa_next_free_vgpr 512
  .amdhsa_next_free_sgpr 102
  .amdhsa_accum_offset 256
  .amdhsa_group_segment_fixed_size 0
  .amdhsa_kernarg_size 120
  .amdhsa_user_sgpr_count 2
  .amdhsa_user_sgpr_kernarg_segment_ptr 1
  .amdhsa_system_sgpr_workgroup_id_x 1
.end_amdhsa_kernel
```
